```python
import torch

def _softmax(x, axis=-1):
    return torch.softmax(x, dim=axis)
def _gelu(x):
    return torch.nn.functional.gelu(x, approximate="tanh")
def _silu(x):
    return torch.nn.functional.silu(x)
def _sigmoid(x):
    return torch.sigmoid(x)
def _layernorm(x, axis=-1, eps=1e-5):
    m = x.mean(dim=axis, keepdim=True)
    v = x.var(dim=axis, keepdim=True, unbiased=False)
    return (x - m) / torch.sqrt(v + eps)
def _scatter_add(tgt, idx, src, axis=0):
    return tgt.clone().index_add_(axis, idx, src)
def _segment_sum(src, seg, n):
    out = torch.zeros((n,) + src.shape[1:], dtype=src.dtype)
    return out.index_add_(0, seg, src)
def _pad(x, pw):
    flat = tuple(v for pair in reversed(pw) for v in pair)
    return torch.nn.functional.pad(x, flat)

kernel_name = 'concat_heads__ssm_conv_s5__ssm_conv_s4__prompt'

def setup_inputs():

    _w = (lambda a: (lambda t: t.to(torch.bfloat16) if t.is_floating_point() else t)(torch.as_tensor(a)))
    def _A_setup():
        B, S, D = 1, 2048, 512
        P = D
        Lambda_re = -0.5 * (lambda _x: torch.exp(torch.as_tensor(_x)))((lambda *s: torch.randn(*s, dtype=torch.bfloat16) * 0.2)(P))
        Lambda_im = (lambda *s: torch.randn(*s, dtype=torch.bfloat16) * 0.4)(P) * 1.0
        B_re = (lambda *s: torch.randn(*s, dtype=torch.bfloat16) * 0.2)(P, D) * (D ** -0.5)
        B_im = (lambda *s: torch.randn(*s, dtype=torch.bfloat16) * 0.2)(P, D) * (D ** -0.5)
        C_re = (lambda *s: torch.randn(*s, dtype=torch.bfloat16) * 0.2)(D, P) * (P ** -0.5)
        C_im = (lambda *s: torch.randn(*s, dtype=torch.bfloat16) * 0.2)(D, P) * (P ** -0.5)
        log_dt = (lambda *s: torch.randn(*s, dtype=torch.bfloat16) * 0.2)(P) * 0.3 - 2.0
        Dskip = (lambda *s: torch.randn(*s, dtype=torch.bfloat16) * 0.05)(D)
        return {
            "x": _w((lambda *s: torch.randn(*s, dtype=torch.bfloat16) * 0.05)(B, S, D)),
            "Lambda_re": _w(Lambda_re),
            "Lambda_im": _w(Lambda_im),
            "B_re": _w(B_re),
            "B_im": _w(B_im),
            "C_re": _w(C_re),
            "C_im": _w(C_im),
            "log_dt": _w(log_dt),
            "Dskip": _w(Dskip),
        }
    _A_in = _A_setup()

    def _B_setup():
        B, L, D, N = 1, 2048, 512, 128
        A_re = -(lambda _x: torch.exp(torch.as_tensor(_x)))((lambda *s: torch.randn(*s, dtype=torch.bfloat16) * 3.2)(D, N))
        A_im = torch.pi * (lambda *s: torch.randn(*s, dtype=torch.bfloat16) * 0.05)(D, N)
        B_re = (lambda *s: torch.randn(*s, dtype=torch.bfloat16) * 0.1)(D, N)
        B_im = (lambda *s: torch.randn(*s, dtype=torch.bfloat16) * 0.1)(D, N)
        C_re = (lambda *s: torch.randn(*s, dtype=torch.bfloat16) * 0.1)(D, N)
        C_im = (lambda *s: torch.randn(*s, dtype=torch.bfloat16) * 0.1)(D, N)
        log_dt = (lambda *s: torch.randn(*s, dtype=torch.bfloat16) * 0.05)(D) * 0.5 - 4.0
        Dskip = (lambda *s: torch.randn(*s, dtype=torch.bfloat16) * 0.05)(D)
        return {
            "u": _w((lambda *s: torch.randn(*s, dtype=torch.bfloat16) * 0.05)(B, L, D)),
            "A_re": _w(A_re),
            "A_im": _w(A_im),
            "B_re": _w(B_re),
            "B_im": _w(B_im),
            "C_re": _w(C_re),
            "C_im": _w(C_im),
            "log_dt": _w(log_dt),
            "Dskip": _w(Dskip),
        }
    _B_in = _B_setup()

    return {
        "A_x": _A_in["x"],
        "A_Lambda_re": _A_in["Lambda_re"],
        "A_Lambda_im": _A_in["Lambda_im"],
        "A_B_re": _A_in["B_re"],
        "A_B_im": _A_in["B_im"],
        "A_C_re": _A_in["C_re"],
        "A_C_im": _A_in["C_im"],
        "A_log_dt": _A_in["log_dt"],
        "A_Dskip": _A_in["Dskip"],
        "B_u": _B_in["u"],
        "B_A_re": _B_in["A_re"],
        "B_A_im": _B_in["A_im"],
        "B_B_re": _B_in["B_re"],
        "B_B_im": _B_in["B_im"],
        "B_C_re": _B_in["C_re"],
        "B_C_im": _B_in["C_im"],
        "B_log_dt": _B_in["log_dt"],
        "B_Dskip": _B_in["Dskip"],
    }

def reference(A_x, A_Lambda_re, A_Lambda_im, A_B_re, A_B_im, A_C_re, A_C_im, A_log_dt, A_Dskip, B_u, B_A_re, B_A_im, B_B_re, B_B_im, B_C_re, B_C_im, B_log_dt, B_Dskip):
    def _A_ref(x, Lambda_re, Lambda_im, B_re, B_im, C_re, C_im, log_dt, Dskip):
        Bsz, L, H = x.shape
        Lam = Lambda_re + 1j * Lambda_im
        Bmat = B_re + 1j * B_im
        Cmat = C_re + 1j * C_im
        dt = torch.exp(log_dt)
        Lam_bar = torch.exp(dt * Lam)
        B_bar = ((Lam_bar - 1.0) / Lam)[:, None] * Bmat
        Bu = torch.einsum("bld,pd->blp", x + 0j, B_bar)
        h = torch.zeros_like(Bu[:, 0, :])
        hs = []
        for t in range(L):
            h = Lam_bar[None, :] * h + Bu[:, t, :]
            hs.append(h)
        hseq = torch.stack(hs, 1)
        y = 2.0 * torch.einsum("blp,dp->bld", hseq, Cmat).real + x * Dskip[None, None, :]
        return y

    def _B_ref(u, A_re, A_im, B_re, B_im, C_re, C_im, log_dt, Dskip):
        Bsz, L, D = u.shape
        dt = torch.exp(log_dt)[:, None]
        A = A_re + 1j * A_im
        Bc = B_re + 1j * B_im
        Cc = C_re + 1j * C_im
        logdA = dt * A
        dB = dt * Bc
        l = (lambda x, dt: x.to(dt))(torch.arange(L), A_re.dtype)
        P = torch.exp(logdA[:, :, None] * l[None, None, :])
        K = torch.einsum("dn,dnl,dn->dl", Cc, P, dB).real
        L2 = 2 * L
        Kp = _pad(K, ((0, 0), (0, L)))
        up = (lambda x, *d: x.permute(*d))(u, 0, 2, 1)
        up = _pad(up, ((0, 0), (0, 0), (0, L)))
        Kf = (lambda x, axes=(-2,-1): torch.fft.rfft2(x.float(), dim=axes))(Kp[:, None, :], axes=(-2, -1))
        Uf = (lambda x, axes=(-2,-1): torch.fft.rfft2(x.float(), dim=axes))(up[:, :, None, :], axes=(-2, -1))
        Yf = Uf * Kf[None, :, :, :]
        y = (lambda x, s, axes=(-2,-1): torch.fft.irfft2(x, s=s, dim=axes).to(torch.bfloat16))(Yf, (1, L2), axes=(-2, -1))[:, :, 0, :L]
        y = (lambda x, *d: x.permute(*d))(y, 0, 2, 1) + u * Dskip[None, None, :]
        return y

    a = _A_ref(A_x, A_Lambda_re, A_Lambda_im, A_B_re, A_B_im, A_C_re, A_C_im, A_log_dt, A_Dskip)
    b = _B_ref(B_u, B_A_re, B_A_im, B_B_re, B_B_im, B_C_re, B_C_im, B_log_dt, B_Dskip)
    return torch.concatenate([a, b], axis=-1)
```

```asm
; @launch grid=(512,1,1) block=(256,1,1) lds=81920
.amdgcn_target "amdgcn-amd-amdhsa--gfx950"
.text
.set WSH_A, 2640
.set WSH_B, 2544

.globl concat_heads__ssm_conv_s5__ssm_conv_s4__prompt_kernel
.p2align 8
.type concat_heads__ssm_conv_s5__ssm_conv_s4__prompt_kernel,@function
concat_heads__ssm_conv_s5__ssm_conv_s4__prompt_kernel:
  s_cmp_ge_u32 s2, 512
  s_cbranch_scc1 L_end
  s_load_dwordx16 s[16:31], s[0:1], 0
  s_load_dwordx16 s[32:47], s[0:1], 64
  s_load_dwordx8 s[48:55], s[0:1], 128
  s_load_dwordx2 s[56:57], s[0:1], 160
  v_lshrrev_b32 v2, 6, v0
  v_and_b32 v1, 63, v0
  v_readfirstlane_b32 s3, v2
  s_and_b32 s6, s2, 7
  s_bfe_u32 s7, s2, 0x50003
  s_cmp_ge_u32 s2, 256
  s_cbranch_scc1 L_typeB
  s_getpc_b64 s[8:9]
L_pcA:
  s_mul_i32 s10, s3, WSH_A
  v_lshlrev_b32 v3, 7, v1
  v_min_u32 v3, WSH_A, v3
  v_add_u32 v3, s10, v3
  global_load_dword v255, v3, s[8:9]
  s_setprio 2
  s_lshr_b32 s4, s7, 4
  s_lshl_b32 s8, s6, 1
  s_add_u32 s4, s4, s8
  s_and_b32 s5, s7, 15
  v_lshrrev_b32 v6, 3, v1
  v_lshlrev_b32 v6, 10, v6
  v_and_b32 v7, 7, v1
  v_lshrrev_b32 v8, 4, v1
  v_xor_b32 v7, v7, v8
  v_lshl_add_u32 v2, v7, 4, v6
  v_xor_b32 v7, 64, v2
  v_add_u32 v3, 7168, v7
  v_add_u32 v4, 14336, v2
  v_add_u32 v5, 21504, v7
  v_and_b32 v99, 31, v1
  s_lshl_b32 s8, s5, 6
  v_lshl_add_u32 v15, v99, 1, s8
  s_lshl_b32 s8, s4, 2
  s_add_u32 s8, s8, s3
  s_lshl_b32 s78, s8, 15
  s_and_b32 s9, s3, 1
  s_lshl_b32 s10, s5, 1
  s_add_u32 s10, s10, s9
  s_lshl_b32 s79, s10, 14
  s_lshl_b32 s80, s3, 12
  s_lshl_b32 s81, s3, 11
  s_add_u32 s81, s81, 49152
  s_getreg_b32 s83, hwreg(HW_REG_XCC_ID)
  s_and_b32 s83, s83, 7
  s_mov_b32 s62, 2097152
  s_mov_b32 s63, 0x00020000
  s_mov_b32 s66, 524288
  s_mov_b32 s67, 0x00020000
  s_cmp_lt_u32 s3, 2
  s_waitcnt lgkmcnt(0)
  s_mov_b32 s60, s16
  s_mov_b32 s61, s17
  s_cselect_b32 s64, s22, s24
  s_cselect_b32 s65, s23, s25
  s_lshl_b32 s38, s6, 7
  global_load_ushort v100, v15, s[18:19]
  global_load_ushort v101, v15, s[20:21]
  global_load_ushort v102, v15, s[30:31]
  v_mov_b32 v120, 8548352
  global_load_dwordx2 v[116:117], v120, s[56:57]
  s_bitcmp1_b32 s2, 3
  s_cselect_b32 s68, s28, s26
  s_cselect_b32 s69, s29, s27
  s_mov_b32 s70, 524288
  s_mov_b32 s71, 0x00020000
  s_bfe_u32 s8, s2, 0x40004
  s_lshl_b32 s8, s8, 15
  s_and_b32 s9, s2, 7
  s_lshl_b32 s9, s9, 7
  s_add_u32 s8, s8, s9
  s_lshl_b32 s9, s3, 13
  s_add_u32 s10, s8, s9
  s_and_b32 s9, s3, 1
  s_lshl_b32 s9, s9, 6
  v_xor_b32 v176, s9, v2
  s_add_u32 s8, s38, 0
  s_and_b32 s8, s8, 0x380
  s_add_u32 m0, s80, 0
  s_add_u32 s8, s8, s78
  buffer_load_dwordx4 v2, s[60:63], s8 offen offset:0 lds
  buffer_load_dwordx4 v3, s[60:63], s8 offen offset:1024 lds
  buffer_load_dwordx4 v4, s[60:63], s8 offen offset:2048 lds
  buffer_load_dwordx4 v5, s[60:63], s8 offen offset:3072 lds
  s_add_u32 s8, s38, 0
  s_and_b32 s8, s8, 0x380
  s_add_u32 m0, s81, 0
  s_add_u32 s8, s8, s79
  buffer_load_dwordx4 v2, s[64:67], s8 offen offset:0 lds
  buffer_load_dwordx4 v3, s[64:67], s8 offen offset:1024 lds
  s_lshl_b32 s9, s3, 10
  s_add_u32 m0, s9, 73728
  s_add_u32 s72, s56, 10485760
  buffer_load_dwordx4 v176, s[68:71], s10 offen nt lds
  s_addc_u32 s73, s57, 0
  s_add_u32 s8, s38, 128
  s_and_b32 s8, s8, 0x380
  s_add_u32 m0, s80, 16384
  s_add_u32 s8, s8, s78
  buffer_load_dwordx4 v2, s[60:63], s8 offen offset:0 lds
  buffer_load_dwordx4 v3, s[60:63], s8 offen offset:1024 lds
  buffer_load_dwordx4 v4, s[60:63], s8 offen offset:2048 lds
  buffer_load_dwordx4 v5, s[60:63], s8 offen offset:3072 lds
  s_add_u32 s8, s38, 128
  s_and_b32 s8, s8, 0x380
  s_add_u32 m0, s81, 8192
  s_add_u32 s8, s8, s79
  buffer_load_dwordx4 v2, s[64:67], s8 offen offset:0 lds
  buffer_load_dwordx4 v3, s[64:67], s8 offen offset:1024 lds
  s_cmp_lg_u32 s3, 0
  s_cbranch_scc1 Ltouch_1
  s_lshl_b32 s10, s4, 17
  s_lshl_b32 s13, s5, 13
  s_add_u32 s10, s10, s13
  v_lshl_add_u32 v108, v1, 7, s10
  global_load_dword v255, v108, s[16:17]
  s_branch Lt2
Ltouch_1:
Lt2:
  v_and_b32 v6, 31, v1
  v_bfe_u32 v7, v6, 2, 1
  v_lshlrev_b32 v7, 4, v7
  v_lshrrev_b32 v8, 3, v6
  v_lshl_add_u32 v7, v8, 2, v7
  v_and_b32 v8, 3, v6
  v_add_u32 v7, v7, v8
  v_lshrrev_b32 v9, 5, v1
  v_bfe_u32 v8, v7, 1, 3
  v_xor_b32 v8, v8, v9
  v_lshlrev_b32 v8, 4, v8
  v_lshl_add_u32 v8, v7, 7, v8
  v_add_u32 v15, s80, v8
  v_bfe_u32 v8, v6, 1, 3
  v_xor_b32 v8, v8, v9
  v_lshlrev_b32 v8, 4, v8
  v_lshl_add_u32 v8, v6, 7, v8
  v_add_u32 v10, 49152, v8
  s_lshl_b32 s8, s3, 1
  v_add_u32 v98, s8, v9
  v_mov_b32 v6, v15
  v_xor_b32 v7, 32, v6
  v_xor_b32 v8, 64, v6
  v_xor_b32 v9, 96, v6
  v_xor_b32 v11, 32, v10
  v_xor_b32 v12, 64, v10
  v_xor_b32 v13, 96, v10
  s_add_u32 s90, s56, 8388608
  s_addc_u32 s91, s57, 0
  s_sub_u32 s12, s4, 1
  s_and_b32 s8, s5, 7
  s_lshl_b32 s9, s8, 1
  s_and_b32 s10, s3, 1
  s_add_u32 s9, s9, s10
  s_lshl_b32 s9, s9, 16
  s_lshl_b32 s10, s3, 13
  s_add_u32 s9, s9, s10
  v_lshl_add_u32 v14, v1, 4, s9
  v_xor_b32 v85, 0x10000, v14
  s_lshl_b32 s8, s8, 10
  s_add_u32 s8, s8, 143360
  v_lshl_add_u32 v15, v1, 4, s8
  s_add_u32 s16, s56, 10485760
  s_addc_u32 s17, s57, 0
  s_add_u32 s18, s56, 10489856
  s_addc_u32 s19, s57, 0
  s_add_u32 s20, s56, 10518528
  s_addc_u32 s21, s57, 0
  s_add_u32 s22, s56, 10522624
  s_addc_u32 s23, s57, 0
  s_waitcnt vmcnt(13)
  v_lshlrev_b32 v100, 16, v100
  v_lshlrev_b32 v101, 16, v101
  v_lshlrev_b32 v102, 16, v102
  v_mul_f32 v102, 0x3fb8aa3b, v102
  v_exp_f32 v102, v102
  v_lshrrev_b32 v106, 5, v1
  v_cvt_pk_bf16_f32 v102, v102, v102
  v_lshlrev_b32 v102, 16, v102
  v_mul_f32 v80, v102, v100
  v_mul_f32 v81, v102, v101
  v_mul_f32 v80, 0x3fb8aa3b, v80
  v_mul_f32 v81, 0x3e22f983, v81
  v_cvt_f32_u32 v106, v106
  v_mul_f32 v106, 0x43000000, v106
  v_mul_f32 v104, v106, v80
  v_mul_f32 v105, v106, v81
  v_exp_f32 v104, v104
  v_fract_f32 v105, v105
  v_cos_f32 v96, v105
  v_sin_f32 v97, v105
  v_mul_f32 v96, v104, v96
  v_mul_f32 v97, v104, v97
  v_mul_f32 v104, 0x43800000, v80
  v_mul_f32 v105, 0x43800000, v81
  v_exp_f32 v104, v104
  v_fract_f32 v105, v105
  v_cos_f32 v94, v105
  v_sin_f32 v95, v105
  v_mul_f32 v94, v104, v94
  v_mul_f32 v95, v104, v95
  v_mul_f32 v104, 1.0, v80
  v_mul_f32 v105, 1.0, v81
  v_exp_f32 v104, v104
  v_fract_f32 v105, v105
  v_cos_f32 v82, v105
  v_sin_f32 v83, v105
  v_mul_f32 v82, v104, v82
  v_mul_f32 v83, v104, v83
  v_mul_f32 v104, 0x41800000, v80
  v_mul_f32 v105, 0x41800000, v81
  v_exp_f32 v104, v104
  v_fract_f32 v105, v105
  v_cos_f32 v90, v105
  v_sin_f32 v91, v105
  v_mul_f32 v90, v104, v90
  v_mul_f32 v91, v104, v91
  v_cvt_f32_u32 v106, v98
  v_mul_f32 v106, 0x41800000, v106
  v_mul_f32 v104, v106, v80
  v_mul_f32 v105, v106, v81
  v_exp_f32 v104, v104
  v_fract_f32 v105, v105
  v_cos_f32 v92, v105
  v_sin_f32 v93, v105
  v_mul_f32 v92, v104, v92
  v_mul_f32 v93, v104, v93
  v_add_f32 v104, -1.0, v82
  v_mul_f32 v105, v100, v100
  v_fmac_f32 v105, v101, v101
  v_rcp_f32 v105, v105
  v_mul_f32 v106, v104, v100
  v_fmac_f32 v106, v83, v101
  v_mul_f32 v107, v83, v100
  v_fma_f32 v107, -v104, v101, v107
  v_add_f32 v105, v105, v105
  v_mul_f32 v86, v106, v105
  v_mul_f32 v87, v107, v105
  v_sub_f32 v84, 0, v83
  v_sub_f32 v88, 0, v87
  v_sub_f32 v89, 0, v86
  v_pk_mul_f32 v[104:105], v[82:83], v[86:87] op_sel:[0,0] op_sel_hi:[0,1]
  v_pk_fma_f32 v[48:49], v[82:83], v[86:87], v[104:105] op_sel:[1,1,0] op_sel_hi:[1,0,1] neg_lo:[1,0,0]
  v_pk_mul_f32 v[104:105], v[82:83], v[48:49] op_sel:[0,0] op_sel_hi:[0,1]
  v_pk_fma_f32 v[50:51], v[82:83], v[48:49], v[104:105] op_sel:[1,1,0] op_sel_hi:[1,0,1] neg_lo:[1,0,0]
  v_pk_mul_f32 v[104:105], v[82:83], v[50:51] op_sel:[0,0] op_sel_hi:[0,1]
  v_pk_fma_f32 v[52:53], v[82:83], v[50:51], v[104:105] op_sel:[1,1,0] op_sel_hi:[1,0,1] neg_lo:[1,0,0]
  v_pk_mul_f32 v[104:105], v[82:83], v[52:53] op_sel:[0,0] op_sel_hi:[0,1]
  v_pk_fma_f32 v[54:55], v[82:83], v[52:53], v[104:105] op_sel:[1,1,0] op_sel_hi:[1,0,1] neg_lo:[1,0,0]
  v_pk_mul_f32 v[104:105], v[82:83], v[54:55] op_sel:[0,0] op_sel_hi:[0,1]
  v_pk_fma_f32 v[56:57], v[82:83], v[54:55], v[104:105] op_sel:[1,1,0] op_sel_hi:[1,0,1] neg_lo:[1,0,0]
  v_pk_mul_f32 v[104:105], v[82:83], v[56:57] op_sel:[0,0] op_sel_hi:[0,1]
  v_pk_fma_f32 v[58:59], v[82:83], v[56:57], v[104:105] op_sel:[1,1,0] op_sel_hi:[1,0,1] neg_lo:[1,0,0]
  v_pk_mul_f32 v[104:105], v[82:83], v[58:59] op_sel:[0,0] op_sel_hi:[0,1]
  v_pk_fma_f32 v[60:61], v[82:83], v[58:59], v[104:105] op_sel:[1,1,0] op_sel_hi:[1,0,1] neg_lo:[1,0,0]
  v_pk_mul_f32 v[104:105], v[82:83], v[60:61] op_sel:[0,0] op_sel_hi:[0,1]
  v_pk_fma_f32 v[62:63], v[82:83], v[60:61], v[104:105] op_sel:[1,1,0] op_sel_hi:[1,0,1] neg_lo:[1,0,0]
  v_pk_mul_f32 v[104:105], v[82:83], v[62:63] op_sel:[0,0] op_sel_hi:[0,1]
  v_pk_fma_f32 v[64:65], v[82:83], v[62:63], v[104:105] op_sel:[1,1,0] op_sel_hi:[1,0,1] neg_lo:[1,0,0]
  v_pk_mul_f32 v[104:105], v[82:83], v[64:65] op_sel:[0,0] op_sel_hi:[0,1]
  v_pk_fma_f32 v[66:67], v[82:83], v[64:65], v[104:105] op_sel:[1,1,0] op_sel_hi:[1,0,1] neg_lo:[1,0,0]
  v_pk_mul_f32 v[104:105], v[82:83], v[66:67] op_sel:[0,0] op_sel_hi:[0,1]
  v_pk_fma_f32 v[68:69], v[82:83], v[66:67], v[104:105] op_sel:[1,1,0] op_sel_hi:[1,0,1] neg_lo:[1,0,0]
  v_pk_mul_f32 v[104:105], v[82:83], v[68:69] op_sel:[0,0] op_sel_hi:[0,1]
  v_pk_fma_f32 v[70:71], v[82:83], v[68:69], v[104:105] op_sel:[1,1,0] op_sel_hi:[1,0,1] neg_lo:[1,0,0]
  v_pk_mul_f32 v[104:105], v[82:83], v[70:71] op_sel:[0,0] op_sel_hi:[0,1]
  v_pk_fma_f32 v[72:73], v[82:83], v[70:71], v[104:105] op_sel:[1,1,0] op_sel_hi:[1,0,1] neg_lo:[1,0,0]
  v_pk_mul_f32 v[104:105], v[82:83], v[72:73] op_sel:[0,0] op_sel_hi:[0,1]
  v_pk_fma_f32 v[74:75], v[82:83], v[72:73], v[104:105] op_sel:[1,1,0] op_sel_hi:[1,0,1] neg_lo:[1,0,0]
  v_pk_mul_f32 v[104:105], v[82:83], v[74:75] op_sel:[0,0] op_sel_hi:[0,1]
  v_pk_fma_f32 v[76:77], v[82:83], v[74:75], v[104:105] op_sel:[1,1,0] op_sel_hi:[1,0,1] neg_lo:[1,0,0]
  v_pk_mul_f32 v[104:105], v[82:83], v[76:77] op_sel:[0,0] op_sel_hi:[0,1]
  v_pk_fma_f32 v[78:79], v[82:83], v[76:77], v[104:105] op_sel:[1,1,0] op_sel_hi:[1,0,1] neg_lo:[1,0,0]
  s_waitcnt vmcnt(6)
  s_barrier
  ds_read_b128 v[128:131], v6 offset:0
  ds_read_b128 v[132:135], v10 offset:0
  ds_read_b128 v[136:139], v10 offset:4096
  ds_read_b128 v[140:143], v7 offset:0
  ds_read_b128 v[144:147], v11 offset:0
  ds_read_b128 v[148:151], v11 offset:4096
  ds_read_b128 v[152:155], v8 offset:0
  ds_read_b128 v[156:159], v12 offset:0
  ds_read_b128 v[160:163], v12 offset:4096
  ds_read_b128 v[164:167], v9 offset:0
  ds_read_b128 v[168:171], v13 offset:0
  ds_read_b128 v[172:175], v13 offset:4096
  s_lshl_b32 s8, s3, 5
  v_xor_b32 v176, s8, v10
  ds_read_b128 v[180:183], v176 offset:24576
  s_and_b32 s8, s2, 255
  s_lshl_b32 s8, s8, 12
  v_lshl_add_u32 v177, v0, 4, s8
  s_add_u32 s8, s38, 256
  s_and_b32 s8, s8, 0x380
  s_add_u32 m0, s80, 32768
  s_add_u32 s8, s8, s78
  buffer_load_dwordx4 v2, s[60:63], s8 offen offset:0 lds
  buffer_load_dwordx4 v3, s[60:63], s8 offen offset:1024 lds
  buffer_load_dwordx4 v4, s[60:63], s8 offen offset:2048 lds
  buffer_load_dwordx4 v5, s[60:63], s8 offen offset:3072 lds
  s_add_u32 s8, s38, 256
  s_and_b32 s8, s8, 0x380
  s_add_u32 m0, s81, 16384
  s_add_u32 s8, s8, s79
  buffer_load_dwordx4 v2, s[64:67], s8 offen offset:0 lds
  buffer_load_dwordx4 v3, s[64:67], s8 offen offset:1024 lds
  s_waitcnt lgkmcnt(11)
  v_mfma_f32_32x32x16_bf16 v[16:31], v[128:131], v[132:135], 0
  s_waitcnt lgkmcnt(10)
  v_mfma_f32_32x32x16_bf16 v[32:47], v[128:131], v[136:139], 0
  s_waitcnt lgkmcnt(0)
  global_store_dwordx4 v177, v[180:183], s[72:73] sc1
  v_mfma_f32_32x32x16_bf16 v[16:31], v[140:143], v[144:147], v[16:31]
  v_mfma_f32_32x32x16_bf16 v[32:47], v[140:143], v[148:151], v[32:47]
  v_mfma_f32_32x32x16_bf16 v[16:31], v[152:155], v[156:159], v[16:31]
  v_mfma_f32_32x32x16_bf16 v[32:47], v[152:155], v[160:163], v[32:47]
  v_mfma_f32_32x32x16_bf16 v[16:31], v[164:167], v[168:171], v[16:31]
  v_mfma_f32_32x32x16_bf16 v[32:47], v[164:167], v[172:175], v[32:47]
  s_waitcnt vmcnt(7)
  s_barrier
  ds_read_b128 v[128:131], v6 offset:16384
  ds_read_b128 v[132:135], v10 offset:8192
  ds_read_b128 v[136:139], v10 offset:12288
  ds_read_b128 v[140:143], v7 offset:16384
  ds_read_b128 v[144:147], v11 offset:8192
  ds_read_b128 v[148:151], v11 offset:12288
  ds_read_b128 v[152:155], v8 offset:16384
  ds_read_b128 v[156:159], v12 offset:8192
  ds_read_b128 v[160:163], v12 offset:12288
  ds_read_b128 v[164:167], v9 offset:16384
  ds_read_b128 v[168:171], v13 offset:8192
  ds_read_b128 v[172:175], v13 offset:12288
  s_add_u32 s8, s38, 384
  s_and_b32 s8, s8, 0x380
  s_add_u32 m0, s80, 0
  s_add_u32 s8, s8, s78
  buffer_load_dwordx4 v2, s[60:63], s8 offen offset:0 lds
  buffer_load_dwordx4 v3, s[60:63], s8 offen offset:1024 lds
  buffer_load_dwordx4 v4, s[60:63], s8 offen offset:2048 lds
  buffer_load_dwordx4 v5, s[60:63], s8 offen offset:3072 lds
  s_add_u32 s8, s38, 384
  s_and_b32 s8, s8, 0x380
  s_add_u32 m0, s81, 24576
  s_add_u32 s8, s8, s79
  buffer_load_dwordx4 v2, s[64:67], s8 offen offset:0 lds
  buffer_load_dwordx4 v3, s[64:67], s8 offen offset:1024 lds
  s_waitcnt lgkmcnt(10)
  v_mfma_f32_32x32x16_bf16 v[16:31], v[128:131], v[132:135], v[16:31]
  s_waitcnt lgkmcnt(9)
  v_mfma_f32_32x32x16_bf16 v[32:47], v[128:131], v[136:139], v[32:47]
  s_waitcnt lgkmcnt(0)
  v_mfma_f32_32x32x16_bf16 v[16:31], v[140:143], v[144:147], v[16:31]
  v_mfma_f32_32x32x16_bf16 v[32:47], v[140:143], v[148:151], v[32:47]
  v_mfma_f32_32x32x16_bf16 v[16:31], v[152:155], v[156:159], v[16:31]
  v_mfma_f32_32x32x16_bf16 v[32:47], v[152:155], v[160:163], v[32:47]
  v_mfma_f32_32x32x16_bf16 v[16:31], v[164:167], v[168:171], v[16:31]
  v_mfma_f32_32x32x16_bf16 v[32:47], v[164:167], v[172:175], v[32:47]
  v_readfirstlane_b32 s76, v116
  v_readfirstlane_b32 s77, v117
  s_add_u32 s76, s76, 0x9e3779b9
  s_mul_i32 s77, s77, 0x85ebca6b
  s_add_u32 s77, s77, 0x7f4a7c18
  s_xor_b32 s39, s77, s83
  s_lshl_b32 s8, s4, 7
  s_add_u32 s8, s8, 131072
  v_and_b32 v216, 15, v1
  v_lshl_add_u32 v216, v216, 3, s8
  s_cmp_lg_u32 s3, 1
  s_cbranch_scc1 Lq_2
  s_lshl_b32 s9, s5, 3
  s_add_u32 s8, s8, s9
  v_mov_b32 v188, s76
  v_mov_b32 v189, s39
  v_mov_b32 v186, s8
  s_mov_b64 exec, 1
  global_store_dwordx2 v186, v[188:189], s[90:91] sc1
  s_mov_b64 exec, -1
Lq_2:
  s_waitcnt vmcnt(6)
  s_and_b32 s8, s2, 255
  s_lshl_b32 s8, s8, 2
  s_add_u32 s8, s8, s3
  s_lshl_b32 s8, s8, 3
  s_add_u32 s8, s8, 143360
  v_mov_b32 v176, s8
  v_mov_b32 v178, s76
  v_mov_b32 v179, s77
  s_mov_b64 exec, 1
  global_store_dwordx2 v176, v[178:179], s[90:91] sc1
  s_mov_b64 exec, -1
  s_barrier
  ds_read_b128 v[128:131], v6 offset:32768
  ds_read_b128 v[132:135], v10 offset:16384
  ds_read_b128 v[136:139], v10 offset:20480
  ds_read_b128 v[140:143], v7 offset:32768
  ds_read_b128 v[144:147], v11 offset:16384
  ds_read_b128 v[148:151], v11 offset:20480
  ds_read_b128 v[152:155], v8 offset:32768
  ds_read_b128 v[156:159], v12 offset:16384
  ds_read_b128 v[160:163], v12 offset:20480
  ds_read_b128 v[164:167], v9 offset:32768
  ds_read_b128 v[168:171], v13 offset:16384
  ds_read_b128 v[172:175], v13 offset:20480
  s_add_u32 s8, s38, 512
  s_and_b32 s8, s8, 0x380
  s_add_u32 m0, s80, 16384
  s_add_u32 s8, s8, s78
  buffer_load_dwordx4 v2, s[60:63], s8 offen offset:0 lds
  buffer_load_dwordx4 v3, s[60:63], s8 offen offset:1024 lds
  buffer_load_dwordx4 v4, s[60:63], s8 offen offset:2048 lds
  buffer_load_dwordx4 v5, s[60:63], s8 offen offset:3072 lds
  s_add_u32 s8, s38, 512
  s_and_b32 s8, s8, 0x380
  s_add_u32 m0, s81, 0
  s_add_u32 s8, s8, s79
  buffer_load_dwordx4 v2, s[64:67], s8 offen offset:0 lds
  buffer_load_dwordx4 v3, s[64:67], s8 offen offset:1024 lds
  s_waitcnt lgkmcnt(10)
  v_mfma_f32_32x32x16_bf16 v[16:31], v[128:131], v[132:135], v[16:31]
  s_waitcnt lgkmcnt(9)
  v_mfma_f32_32x32x16_bf16 v[32:47], v[128:131], v[136:139], v[32:47]
  s_waitcnt lgkmcnt(0)
  v_mfma_f32_32x32x16_bf16 v[16:31], v[140:143], v[144:147], v[16:31]
  v_mfma_f32_32x32x16_bf16 v[32:47], v[140:143], v[148:151], v[32:47]
  v_mfma_f32_32x32x16_bf16 v[16:31], v[152:155], v[156:159], v[16:31]
  v_mfma_f32_32x32x16_bf16 v[32:47], v[152:155], v[160:163], v[32:47]
  v_mfma_f32_32x32x16_bf16 v[16:31], v[164:167], v[168:171], v[16:31]
  v_mfma_f32_32x32x16_bf16 v[32:47], v[164:167], v[172:175], v[32:47]
  s_lshl_b32 s8, s4, 4
  s_add_u32 s8, s8, s5
  s_lshl_b32 s8, s8, 9
  v_lshl_add_u32 v208, v99, 4, s8
  v_lshrrev_b32 v108, 5, v1
  v_add_u32 v108, 1, v108
  v_lshlrev_b32 v108, 13, v108
  v_sub_u32 v208, v208, v108
  v_mov_b32 v108, s76
  v_mov_b32 v109, s77
  v_cmp_le_i32 vcc, 0, v208
  s_nop 1
  v_cndmask_b32 v192, 0, v108, vcc
  v_cndmask_b32 v193, 0, v109, vcc
  v_subrev_u32 v209, 16384, v208
  v_cmp_le_i32 vcc, 0, v209
  s_nop 1
  v_cndmask_b32 v194, 0, v108, vcc
  v_cndmask_b32 v195, 0, v109, vcc
  v_subrev_u32 v210, 32768, v208
  v_cmp_le_i32 vcc, 0, v210
  s_nop 1
  v_cndmask_b32 v196, 0, v108, vcc
  v_cndmask_b32 v197, 0, v109, vcc
  v_subrev_u32 v211, 49152, v208
  v_cmp_le_i32 vcc, 0, v211
  s_nop 1
  v_cndmask_b32 v198, 0, v108, vcc
  v_cndmask_b32 v199, 0, v109, vcc
  v_subrev_u32 v212, 65536, v208
  v_cmp_le_i32 vcc, 0, v212
  s_nop 1
  v_cndmask_b32 v200, 0, v108, vcc
  v_cndmask_b32 v201, 0, v109, vcc
  v_subrev_u32 v213, 81920, v208
  v_cmp_le_i32 vcc, 0, v213
  s_nop 1
  v_cndmask_b32 v202, 0, v108, vcc
  v_cndmask_b32 v203, 0, v109, vcc
  v_subrev_u32 v214, 98304, v208
  v_cmp_le_i32 vcc, 0, v214
  s_nop 1
  v_cndmask_b32 v204, 0, v108, vcc
  v_cndmask_b32 v205, 0, v109, vcc
  v_subrev_u32 v215, 114688, v208
  v_cmp_le_i32 vcc, 0, v215
  s_nop 1
  v_cndmask_b32 v206, 0, v108, vcc
  v_cndmask_b32 v207, 0, v109, vcc
  s_waitcnt vmcnt(7)
  s_barrier
  ds_read_b128 v[128:131], v6 offset:0
  ds_read_b128 v[132:135], v10 offset:24576
  ds_read_b128 v[136:139], v10 offset:28672
  ds_read_b128 v[140:143], v7 offset:0
  ds_read_b128 v[144:147], v11 offset:24576
  ds_read_b128 v[148:151], v11 offset:28672
  ds_read_b128 v[152:155], v8 offset:0
  ds_read_b128 v[156:159], v12 offset:24576
  ds_read_b128 v[160:163], v12 offset:28672
  ds_read_b128 v[164:167], v9 offset:0
  ds_read_b128 v[168:171], v13 offset:24576
  ds_read_b128 v[172:175], v13 offset:28672
  s_add_u32 s8, s38, 640
  s_and_b32 s8, s8, 0x380
  s_add_u32 m0, s80, 32768
  s_add_u32 s8, s8, s78
  buffer_load_dwordx4 v2, s[60:63], s8 offen offset:0 lds
  buffer_load_dwordx4 v3, s[60:63], s8 offen offset:1024 lds
  buffer_load_dwordx4 v4, s[60:63], s8 offen offset:2048 lds
  buffer_load_dwordx4 v5, s[60:63], s8 offen offset:3072 lds
  s_add_u32 s8, s38, 640
  s_and_b32 s8, s8, 0x380
  s_add_u32 m0, s81, 8192
  s_add_u32 s8, s8, s79
  buffer_load_dwordx4 v2, s[64:67], s8 offen offset:0 lds
  buffer_load_dwordx4 v3, s[64:67], s8 offen offset:1024 lds
  s_waitcnt lgkmcnt(10)
  v_mfma_f32_32x32x16_bf16 v[16:31], v[128:131], v[132:135], v[16:31]
  s_waitcnt lgkmcnt(9)
  v_mfma_f32_32x32x16_bf16 v[32:47], v[128:131], v[136:139], v[32:47]
  s_waitcnt lgkmcnt(0)
  v_mfma_f32_32x32x16_bf16 v[16:31], v[140:143], v[144:147], v[16:31]
  v_mfma_f32_32x32x16_bf16 v[32:47], v[140:143], v[148:151], v[32:47]
  v_mfma_f32_32x32x16_bf16 v[16:31], v[152:155], v[156:159], v[16:31]
  v_mfma_f32_32x32x16_bf16 v[32:47], v[152:155], v[160:163], v[32:47]
  v_mfma_f32_32x32x16_bf16 v[16:31], v[164:167], v[168:171], v[16:31]
  v_mfma_f32_32x32x16_bf16 v[32:47], v[164:167], v[172:175], v[32:47]
  s_waitcnt vmcnt(6)
  s_barrier
  ds_read_b128 v[128:131], v6 offset:16384
  ds_read_b128 v[132:135], v10 offset:0
  ds_read_b128 v[136:139], v10 offset:4096
  ds_read_b128 v[140:143], v7 offset:16384
  ds_read_b128 v[144:147], v11 offset:0
  ds_read_b128 v[148:151], v11 offset:4096
  ds_read_b128 v[152:155], v8 offset:16384
  ds_read_b128 v[156:159], v12 offset:0
  ds_read_b128 v[160:163], v12 offset:4096
  ds_read_b128 v[164:167], v9 offset:16384
  ds_read_b128 v[168:171], v13 offset:0
  ds_read_b128 v[172:175], v13 offset:4096
  s_lshl_b32 s8, s7, 3
  s_lshl_b32 s9, s3, 1
  s_add_u32 s8, s8, s9
  v_lshrrev_b32 v180, 5, v1
  v_add_u32 v180, s8, v180
  v_bfe_u32 v181, v1, 3, 2
  v_lshl_add_u32 v181, v180, 2, v181
  v_lshlrev_b32 v181, 3, v181
  v_add_u32 v181, 143360, v181
  v_lshlrev_b32 v185, 7, v99
  v_lshl_add_u32 v185, v180, 12, v185
  global_load_dwordx2 v[182:183], v181, s[90:91] sc1
  s_add_u32 s8, s38, 768
  s_and_b32 s8, s8, 0x380
  s_add_u32 m0, s80, 0
  s_add_u32 s8, s8, s78
  buffer_load_dwordx4 v2, s[60:63], s8 offen offset:0 lds
  buffer_load_dwordx4 v3, s[60:63], s8 offen offset:1024 lds
  buffer_load_dwordx4 v4, s[60:63], s8 offen offset:2048 lds
  buffer_load_dwordx4 v5, s[60:63], s8 offen offset:3072 lds
  s_add_u32 s8, s38, 768
  s_and_b32 s8, s8, 0x380
  s_add_u32 m0, s81, 16384
  s_add_u32 s8, s8, s79
  buffer_load_dwordx4 v2, s[64:67], s8 offen offset:0 lds
  buffer_load_dwordx4 v3, s[64:67], s8 offen offset:1024 lds
  s_waitcnt lgkmcnt(10)
  v_mfma_f32_32x32x16_bf16 v[16:31], v[128:131], v[132:135], v[16:31]
  s_waitcnt lgkmcnt(9)
  v_mfma_f32_32x32x16_bf16 v[32:47], v[128:131], v[136:139], v[32:47]
  s_waitcnt lgkmcnt(0)
  v_mfma_f32_32x32x16_bf16 v[16:31], v[140:143], v[144:147], v[16:31]
  v_mfma_f32_32x32x16_bf16 v[32:47], v[140:143], v[148:151], v[32:47]
  v_mfma_f32_32x32x16_bf16 v[16:31], v[152:155], v[156:159], v[16:31]
  v_mfma_f32_32x32x16_bf16 v[32:47], v[152:155], v[160:163], v[32:47]
  v_mfma_f32_32x32x16_bf16 v[16:31], v[164:167], v[168:171], v[16:31]
  v_mfma_f32_32x32x16_bf16 v[32:47], v[164:167], v[172:175], v[32:47]
  s_waitcnt vmcnt(7)
  s_barrier
  ds_read_b128 v[128:131], v6 offset:32768
  ds_read_b128 v[132:135], v10 offset:8192
  ds_read_b128 v[136:139], v10 offset:12288
  ds_read_b128 v[140:143], v7 offset:32768
  ds_read_b128 v[144:147], v11 offset:8192
  ds_read_b128 v[148:151], v11 offset:12288
  ds_read_b128 v[152:155], v8 offset:32768
  ds_read_b128 v[156:159], v12 offset:8192
  ds_read_b128 v[160:163], v12 offset:12288
  ds_read_b128 v[164:167], v9 offset:32768
  ds_read_b128 v[168:171], v13 offset:8192
  ds_read_b128 v[172:175], v13 offset:12288
  s_cmp_lg_u32 s3, 0
  s_cbranch_scc1 Lq_3
  global_load_dwordx4 v[100:103], v15, s[90:91] sc1
Lq_3:
  s_add_u32 s8, s38, 896
  s_and_b32 s8, s8, 0x380
  s_add_u32 m0, s80, 16384
  s_add_u32 s8, s8, s78
  buffer_load_dwordx4 v2, s[60:63], s8 offen offset:0 lds
  buffer_load_dwordx4 v3, s[60:63], s8 offen offset:1024 lds
  buffer_load_dwordx4 v4, s[60:63], s8 offen offset:2048 lds
  buffer_load_dwordx4 v5, s[60:63], s8 offen offset:3072 lds
  s_add_u32 s8, s38, 896
  s_and_b32 s8, s8, 0x380
  s_add_u32 m0, s81, 24576
  s_add_u32 s8, s8, s79
  buffer_load_dwordx4 v2, s[64:67], s8 offen offset:0 lds
  buffer_load_dwordx4 v3, s[64:67], s8 offen offset:1024 lds
  s_waitcnt lgkmcnt(10)
  v_mfma_f32_32x32x16_bf16 v[16:31], v[128:131], v[132:135], v[16:31]
  s_waitcnt lgkmcnt(9)
  v_mfma_f32_32x32x16_bf16 v[32:47], v[128:131], v[136:139], v[32:47]
  s_waitcnt lgkmcnt(0)
  v_mfma_f32_32x32x16_bf16 v[16:31], v[140:143], v[144:147], v[16:31]
  v_mfma_f32_32x32x16_bf16 v[32:47], v[140:143], v[148:151], v[32:47]
  v_mfma_f32_32x32x16_bf16 v[16:31], v[152:155], v[156:159], v[16:31]
  v_mfma_f32_32x32x16_bf16 v[32:47], v[152:155], v[160:163], v[32:47]
  v_mfma_f32_32x32x16_bf16 v[16:31], v[164:167], v[168:171], v[16:31]
  v_mfma_f32_32x32x16_bf16 v[32:47], v[164:167], v[172:175], v[32:47]
  s_waitcnt vmcnt(12)
  v_cmp_eq_u32 s[8:9], s76, v182
  v_cmp_eq_u32 s[10:11], s77, v183
  s_and_b64 vcc, s[8:9], s[10:11]
  s_mov_b32 s68, s72
  s_mov_b32 s69, s73
  s_mov_b32 s70, 1048576
  v_cndmask_b32 v185, -16, v185, vcc
  buffer_load_dword v252, v185, s[68:71], 0 offen
  s_waitcnt vmcnt(7)
  s_barrier
  ds_read_b128 v[128:131], v6 offset:0
  ds_read_b128 v[132:135], v10 offset:16384
  ds_read_b128 v[136:139], v10 offset:20480
  ds_read_b128 v[140:143], v7 offset:0
  ds_read_b128 v[144:147], v11 offset:16384
  ds_read_b128 v[148:151], v11 offset:20480
  ds_read_b128 v[152:155], v8 offset:0
  ds_read_b128 v[156:159], v12 offset:16384
  ds_read_b128 v[160:163], v12 offset:20480
  ds_read_b128 v[164:167], v9 offset:0
  ds_read_b128 v[168:171], v13 offset:16384
  ds_read_b128 v[172:175], v13 offset:20480
  s_waitcnt lgkmcnt(10)
  v_mfma_f32_32x32x16_bf16 v[16:31], v[128:131], v[132:135], v[16:31]
  s_waitcnt lgkmcnt(9)
  v_mfma_f32_32x32x16_bf16 v[32:47], v[128:131], v[136:139], v[32:47]
  s_waitcnt lgkmcnt(0)
  v_mfma_f32_32x32x16_bf16 v[16:31], v[140:143], v[144:147], v[16:31]
  v_mfma_f32_32x32x16_bf16 v[32:47], v[140:143], v[148:151], v[32:47]
  v_mfma_f32_32x32x16_bf16 v[16:31], v[152:155], v[156:159], v[16:31]
  v_mfma_f32_32x32x16_bf16 v[32:47], v[152:155], v[160:163], v[32:47]
  v_mfma_f32_32x32x16_bf16 v[16:31], v[164:167], v[168:171], v[16:31]
  v_mfma_f32_32x32x16_bf16 v[32:47], v[164:167], v[172:175], v[32:47]
  v_mov_b32 v121, 32768
  s_cmp_lg_u32 s3, 0
  s_cbranch_scc1 Lq_4
  s_waitcnt vmcnt(6)
  v_xor_b32 v100, s76, v100
  v_xor_b32 v101, s77, v101
  v_xor_b32 v102, s76, v102
  v_xor_b32 v103, s77, v103
  v_or_b32 v101, v101, v103
  v_and_b32 v101, -8, v101
  v_or3_b32 v100, v100, v101, v102
  v_cmp_ne_u32 s[8:9], 0, v100
  s_cmp_eq_u64 s[8:9], 0
  s_cselect_b32 s13, 1, 0
  v_mov_b32 v120, s13
  ds_write_b32 v121, v120
  s_waitcnt lgkmcnt(0)
Lq_4:
  s_waitcnt vmcnt(1)
  s_barrier
  ds_read_b128 v[128:131], v6 offset:16384
  ds_read_b128 v[132:135], v10 offset:24576
  ds_read_b128 v[136:139], v10 offset:28672
  ds_read_b128 v[140:143], v7 offset:16384
  ds_read_b128 v[144:147], v11 offset:24576
  ds_read_b128 v[148:151], v11 offset:28672
  ds_read_b128 v[152:155], v8 offset:16384
  ds_read_b128 v[156:159], v12 offset:24576
  ds_read_b128 v[160:163], v12 offset:28672
  ds_read_b128 v[164:167], v9 offset:16384
  ds_read_b128 v[168:171], v13 offset:24576
  ds_read_b128 v[172:175], v13 offset:28672
  s_lshl_b32 s8, s4, 2
  s_add_u32 s8, s8, s3
  s_lshl_b32 s8, s8, 4
  s_add_u32 s8, s8, s5
  s_lshl_b32 s8, s8, 12
  v_lshl_add_u32 v184, v99, 7, s8
  global_load_dword v253, v184, s[56:57]
  s_lshr_b32 s8, s8, 16
  s_lshl_b32 s8, s8, 7
  s_add_u32 s8, s8, 135168
  v_mov_b32 v186, s8
  global_load_dword v251, v186, s[90:91]
  ds_read_b32 v120, v121
  s_waitcnt lgkmcnt(11)
  v_mfma_f32_32x32x16_bf16 v[16:31], v[128:131], v[132:135], v[16:31]
  s_waitcnt lgkmcnt(10)
  v_mfma_f32_32x32x16_bf16 v[32:47], v[128:131], v[136:139], v[32:47]
  s_waitcnt lgkmcnt(0)
  v_mfma_f32_32x32x16_bf16 v[16:31], v[140:143], v[144:147], v[16:31]
  v_mfma_f32_32x32x16_bf16 v[32:47], v[140:143], v[148:151], v[32:47]
  v_mfma_f32_32x32x16_bf16 v[16:31], v[152:155], v[156:159], v[16:31]
  v_mfma_f32_32x32x16_bf16 v[32:47], v[152:155], v[160:163], v[32:47]
  v_mfma_f32_32x32x16_bf16 v[16:31], v[164:167], v[168:171], v[16:31]
  v_mfma_f32_32x32x16_bf16 v[32:47], v[164:167], v[172:175], v[32:47]
  v_readfirstlane_b32 s8, v120
  s_and_b32 s85, s8, 1
  v_lshl_add_u32 v2, v1, 3, s80
  v_lshlrev_b32 v3, 3, v99
  s_lshl_b32 s8, s4, 4
  s_add_u32 s12, s8, s5
  s_lshl_b32 s8, s12, 9
  v_lshl_add_u32 v4, v99, 4, s8
  v_mov_b32 v121, s76
  v_mov_b32 v123, s77
  s_nop 0
  v_fmac_f32 v17, v82, v16
  v_fmac_f32 v33, v82, v32
  v_fmac_f32 v17, v84, v32
  v_fmac_f32 v33, v83, v16
  v_fmac_f32 v18, v82, v17
  v_fmac_f32 v34, v82, v33
  v_fmac_f32 v18, v84, v33
  v_fmac_f32 v34, v83, v17
  v_fmac_f32 v19, v82, v18
  v_fmac_f32 v35, v82, v34
  v_fmac_f32 v19, v84, v34
  v_fmac_f32 v35, v83, v18
  v_fmac_f32 v20, v82, v19
  v_fmac_f32 v36, v82, v35
  v_fmac_f32 v20, v84, v35
  v_fmac_f32 v36, v83, v19
  v_fmac_f32 v21, v82, v20
  v_fmac_f32 v37, v82, v36
  v_fmac_f32 v21, v84, v36
  v_fmac_f32 v37, v83, v20
  v_fmac_f32 v22, v82, v21
  v_fmac_f32 v38, v82, v37
  v_fmac_f32 v22, v84, v37
  v_fmac_f32 v38, v83, v21
  v_fmac_f32 v23, v82, v22
  v_fmac_f32 v39, v82, v38
  v_fmac_f32 v23, v84, v38
  v_fmac_f32 v39, v83, v22
  v_fmac_f32 v24, v82, v23
  v_fmac_f32 v40, v82, v39
  v_fmac_f32 v24, v84, v39
  v_fmac_f32 v40, v83, v23
  v_fmac_f32 v25, v82, v24
  v_fmac_f32 v41, v82, v40
  v_fmac_f32 v25, v84, v40
  v_fmac_f32 v41, v83, v24
  v_fmac_f32 v26, v82, v25
  v_fmac_f32 v42, v82, v41
  v_fmac_f32 v26, v84, v41
  v_fmac_f32 v42, v83, v25
  v_fmac_f32 v27, v82, v26
  v_fmac_f32 v43, v82, v42
  v_fmac_f32 v27, v84, v42
  v_fmac_f32 v43, v83, v26
  v_fmac_f32 v28, v82, v27
  v_fmac_f32 v44, v82, v43
  v_fmac_f32 v28, v84, v43
  v_fmac_f32 v44, v83, v27
  v_fmac_f32 v29, v82, v28
  v_fmac_f32 v45, v82, v44
  v_fmac_f32 v29, v84, v44
  v_fmac_f32 v45, v83, v28
  v_fmac_f32 v30, v82, v29
  v_fmac_f32 v46, v82, v45
  v_fmac_f32 v30, v84, v45
  v_fmac_f32 v46, v83, v29
  v_fmac_f32 v31, v82, v30
  v_fmac_f32 v47, v82, v46
  v_fmac_f32 v31, v84, v46
  v_fmac_f32 v47, v83, v30
  ds_write2_b32 v2, v31, v47 offset0:0 offset1:1
  s_waitcnt lgkmcnt(0)
  s_barrier
  ds_read_b64 v[100:101], v3 offset:0
  ds_read_b64 v[102:103], v3 offset:256
  ds_read_b64 v[104:105], v3 offset:4096
  ds_read_b64 v[106:107], v3 offset:4352
  ds_read_b64 v[108:109], v3 offset:8192
  ds_read_b64 v[110:111], v3 offset:8448
  ds_read_b64 v[112:113], v3 offset:12288
  ds_read_b64 v[114:115], v3 offset:12544
  s_mov_b32 s40, s90
  s_mov_b32 s41, s91
  s_mov_b32 s42, 131072
  s_mov_b32 s43, 0x00020000
  v_sub_f32 v84, 0, v95
  s_waitcnt lgkmcnt(6)
  v_pk_fma_f32 v[116:117], v[90:91], v[100:101], v[102:103] op_sel:[0,0,0] op_sel_hi:[0,1,1]
  v_pk_fma_f32 v[102:103], v[90:91], v[100:101], v[116:117] op_sel:[1,1,0] op_sel_hi:[1,0,1] neg_lo:[1,0,0]
  s_waitcnt lgkmcnt(5)
  v_pk_fma_f32 v[116:117], v[90:91], v[102:103], v[104:105] op_sel:[0,0,0] op_sel_hi:[0,1,1]
  v_pk_fma_f32 v[104:105], v[90:91], v[102:103], v[116:117] op_sel:[1,1,0] op_sel_hi:[1,0,1] neg_lo:[1,0,0]
  s_waitcnt lgkmcnt(4)
  v_pk_fma_f32 v[116:117], v[90:91], v[104:105], v[106:107] op_sel:[0,0,0] op_sel_hi:[0,1,1]
  v_pk_fma_f32 v[106:107], v[90:91], v[104:105], v[116:117] op_sel:[1,1,0] op_sel_hi:[1,0,1] neg_lo:[1,0,0]
  s_waitcnt lgkmcnt(3)
  v_pk_fma_f32 v[116:117], v[90:91], v[106:107], v[108:109] op_sel:[0,0,0] op_sel_hi:[0,1,1]
  v_pk_fma_f32 v[108:109], v[90:91], v[106:107], v[116:117] op_sel:[1,1,0] op_sel_hi:[1,0,1] neg_lo:[1,0,0]
  s_waitcnt lgkmcnt(2)
  v_pk_fma_f32 v[116:117], v[90:91], v[108:109], v[110:111] op_sel:[0,0,0] op_sel_hi:[0,1,1]
  v_pk_fma_f32 v[110:111], v[90:91], v[108:109], v[116:117] op_sel:[1,1,0] op_sel_hi:[1,0,1] neg_lo:[1,0,0]
  s_waitcnt lgkmcnt(1)
  v_pk_fma_f32 v[116:117], v[90:91], v[110:111], v[112:113] op_sel:[0,0,0] op_sel_hi:[0,1,1]
  v_pk_fma_f32 v[112:113], v[90:91], v[110:111], v[116:117] op_sel:[1,1,0] op_sel_hi:[1,0,1] neg_lo:[1,0,0]
  s_waitcnt lgkmcnt(0)
  v_pk_fma_f32 v[116:117], v[90:91], v[112:113], v[114:115] op_sel:[0,0,0] op_sel_hi:[0,1,1]
  v_pk_fma_f32 v[114:115], v[90:91], v[112:113], v[116:117] op_sel:[1,1,0] op_sel_hi:[1,0,1] neg_lo:[1,0,0]
  v_mov_b32 v120, v114
  v_mov_b32 v122, v115
  s_cmp_lg_u32 s3, 0
  s_cbranch_scc1 Lnopub_5
  s_mov_b32 exec_hi, 0
  global_store_dwordx4 v4, v[120:123], s[90:91] sc1
  s_mov_b64 exec, -1
  global_load_dwordx2 v[218:219], v216, s[90:91] sc1
  s_branch Lj0_6
Lnopub_5:
  s_cmp_eq_u32 s85, 0
  s_cbranch_scc1 Lj0_6
  global_load_dwordx4 v[128:131], v14, s[16:17] offset:0
  global_load_dwordx4 v[132:135], v85, s[16:17] offset:0
  global_load_dwordx4 v[136:139], v14, s[16:17] offset:1024
  global_load_dwordx4 v[140:143], v85, s[16:17] offset:1024
  global_load_dwordx4 v[144:147], v14, s[20:21] offset:0
  global_load_dwordx4 v[148:151], v85, s[20:21] offset:0
  global_load_dwordx4 v[152:155], v14, s[20:21] offset:1024
  global_load_dwordx4 v[156:159], v85, s[20:21] offset:1024
  global_load_dwordx4 v[160:163], v14, s[16:17] offset:2048
  global_load_dwordx4 v[164:167], v85, s[16:17] offset:2048
  global_load_dwordx4 v[168:171], v14, s[16:17] offset:3072
  global_load_dwordx4 v[172:175], v85, s[16:17] offset:3072
  global_load_dwordx4 v[176:179], v14, s[20:21] offset:2048
  global_load_dwordx4 v[180:183], v85, s[20:21] offset:2048
  global_load_dwordx4 v[184:187], v14, s[20:21] offset:3072
  global_load_dwordx4 v[188:191], v85, s[20:21] offset:3072
Lj0_6:
  v_mov_b32 v118, 0
  v_mov_b32 v119, 0
  v_cmp_eq_u32 vcc, 1, v98
  s_nop 1
  v_cndmask_b32 v118, v118, v100, vcc
  v_cndmask_b32 v119, v119, v101, vcc
  v_cmp_eq_u32 vcc, 2, v98
  s_nop 1
  v_cndmask_b32 v118, v118, v102, vcc
  v_cndmask_b32 v119, v119, v103, vcc
  v_cmp_eq_u32 vcc, 3, v98
  s_nop 1
  v_cndmask_b32 v118, v118, v104, vcc
  v_cndmask_b32 v119, v119, v105, vcc
  v_cmp_eq_u32 vcc, 4, v98
  s_nop 1
  v_cndmask_b32 v118, v118, v106, vcc
  v_cndmask_b32 v119, v119, v107, vcc
  v_cmp_eq_u32 vcc, 5, v98
  s_nop 1
  v_cndmask_b32 v118, v118, v108, vcc
  v_cndmask_b32 v119, v119, v109, vcc
  v_cmp_eq_u32 vcc, 6, v98
  s_nop 1
  v_cndmask_b32 v118, v118, v110, vcc
  v_cndmask_b32 v119, v119, v111, vcc
  v_cmp_eq_u32 vcc, 7, v98
  s_nop 1
  v_cndmask_b32 v118, v118, v112, vcc
  v_cndmask_b32 v119, v119, v113, vcc
  v_mul_f32 v116, v86, v16
  v_fmac_f32 v116, v88, v32
  v_mul_f32 v32, v89, v32
  v_fmac_f32 v32, v88, v16
  v_mov_b32 v16, v116
  v_mul_f32 v117, v86, v17
  v_fmac_f32 v117, v88, v33
  v_mul_f32 v33, v89, v33
  v_fmac_f32 v33, v88, v17
  v_mov_b32 v17, v117
  s_cmp_lg_u32 s3, 0
  s_cbranch_scc1 Lw0i_7
  buffer_load_dwordx4 v[128:131], v208, s[40:43], 0 offen sc1
  buffer_load_dwordx4 v[132:135], v209, s[40:43], 0 offen sc1
  buffer_load_dwordx4 v[136:139], v210, s[40:43], 0 offen sc1
  buffer_load_dwordx4 v[140:143], v211, s[40:43], 0 offen sc1
  buffer_load_dwordx4 v[144:147], v212, s[40:43], 0 offen sc1
  buffer_load_dwordx4 v[148:151], v213, s[40:43], 0 offen sc1
  buffer_load_dwordx4 v[152:155], v214, s[40:43], 0 offen sc1
  buffer_load_dwordx4 v[156:159], v215, s[40:43], 0 offen sc1
Lw0i_7:
  v_mul_f32 v116, v86, v18
  v_fmac_f32 v116, v88, v34
  v_mul_f32 v34, v89, v34
  v_fmac_f32 v34, v88, v18
  v_mov_b32 v18, v116
  v_mul_f32 v117, v86, v19
  v_fmac_f32 v117, v88, v35
  v_mul_f32 v35, v89, v35
  v_fmac_f32 v35, v88, v19
  v_mov_b32 v19, v117
  v_mul_f32 v116, v86, v20
  v_fmac_f32 v116, v88, v36
  v_mul_f32 v36, v89, v36
  v_fmac_f32 v36, v88, v20
  v_mov_b32 v20, v116
  v_mul_f32 v117, v86, v21
  v_fmac_f32 v117, v88, v37
  v_mul_f32 v37, v89, v37
  v_fmac_f32 v37, v88, v21
  v_mov_b32 v21, v117
  v_mul_f32 v116, v86, v22
  v_fmac_f32 v116, v88, v38
  v_mul_f32 v38, v89, v38
  v_fmac_f32 v38, v88, v22
  v_mov_b32 v22, v116
  v_mul_f32 v117, v86, v23
  v_fmac_f32 v117, v88, v39
  v_mul_f32 v39, v89, v39
  v_fmac_f32 v39, v88, v23
  v_mov_b32 v23, v117
  v_mul_f32 v116, v86, v24
  v_fmac_f32 v116, v88, v40
  v_mul_f32 v40, v89, v40
  v_fmac_f32 v40, v88, v24
  v_mov_b32 v24, v116
  v_mul_f32 v117, v86, v25
  v_fmac_f32 v117, v88, v41
  v_mul_f32 v41, v89, v41
  v_fmac_f32 v41, v88, v25
  v_mov_b32 v25, v117
  v_mul_f32 v116, v86, v26
  v_fmac_f32 v116, v88, v42
  v_mul_f32 v42, v89, v42
  v_fmac_f32 v42, v88, v26
  v_mov_b32 v26, v116
  v_mul_f32 v117, v86, v27
  v_fmac_f32 v117, v88, v43
  v_mul_f32 v43, v89, v43
  v_fmac_f32 v43, v88, v27
  v_mov_b32 v27, v117
  v_mul_f32 v116, v86, v28
  v_fmac_f32 v116, v88, v44
  v_mul_f32 v44, v89, v44
  v_fmac_f32 v44, v88, v28
  v_mov_b32 v28, v116
  v_mul_f32 v117, v86, v29
  v_fmac_f32 v117, v88, v45
  v_mul_f32 v45, v89, v45
  v_fmac_f32 v45, v88, v29
  v_mov_b32 v29, v117
  v_mul_f32 v116, v86, v30
  v_fmac_f32 v116, v88, v46
  v_mul_f32 v46, v89, v46
  v_fmac_f32 v46, v88, v30
  v_mov_b32 v30, v116
  v_mul_f32 v117, v86, v31
  v_fmac_f32 v117, v88, v47
  v_mul_f32 v47, v89, v47
  v_fmac_f32 v47, v88, v31
  v_mov_b32 v31, v117
  v_lshrrev_b32 v9, 5, v1
  v_lshlrev_b32 v9, 11, v9
  v_lshl_add_u32 v9, v99, 5, v9
  v_add_u32 v9, s80, v9
  v_bfe_u32 v10, v1, 4, 1
  v_lshlrev_b32 v10, 11, v10
  v_lshrrev_b32 v11, 5, v1
  v_lshl_add_u32 v10, v11, 8, v10
  v_bfe_u32 v11, v1, 2, 2
  v_lshl_add_u32 v10, v11, 5, v10
  v_and_b32 v11, 3, v1
  v_lshl_add_u32 v10, v11, 3, v10
  v_add_u32 v10, s80, v10
  s_lshl_b32 s8, s4, 2
  s_add_u32 s8, s8, s3
  s_lshl_b32 s8, s8, 4
  s_add_u32 s8, s8, s5
  s_lshl_b32 s9, s8, 12
  v_lshl_add_u32 v11, v1, 4, s9
  s_lshl_b32 s8, s8, 3
  s_add_u32 s8, s8, 135168
  v_mov_b32 v12, s8
  v_mov_b32 v80, s76
  v_mov_b32 v81, s77
  s_cmp_lg_u32 s3, 0
  s_cbranch_scc1 Llb_skip_8
  s_mov_b32 s13, 0
  buffer_load_dwordx4 v[160:163], v208, s[40:43], 0 offen sc1
  buffer_load_dwordx4 v[164:167], v209, s[40:43], 0 offen sc1
  buffer_load_dwordx4 v[168:171], v210, s[40:43], 0 offen sc1
  buffer_load_dwordx4 v[172:175], v211, s[40:43], 0 offen sc1
  buffer_load_dwordx4 v[176:179], v212, s[40:43], 0 offen sc1
  buffer_load_dwordx4 v[180:183], v213, s[40:43], 0 offen sc1
  buffer_load_dwordx4 v[184:187], v214, s[40:43], 0 offen sc1
  buffer_load_dwordx4 v[188:191], v215, s[40:43], 0 offen sc1
Llb_9:
  s_waitcnt vmcnt(8)
  v_xor_b32 v120, v192, v129
  v_xor_b32 v121, v193, v131
  v_or_b32 v122, v120, v121
  v_xor_b32 v120, v194, v133
  v_xor_b32 v121, v195, v135
  v_or3_b32 v122, v120, v121, v122
  v_xor_b32 v120, v196, v137
  v_xor_b32 v121, v197, v139
  v_or3_b32 v122, v120, v121, v122
  v_xor_b32 v120, v198, v141
  v_xor_b32 v121, v199, v143
  v_or3_b32 v122, v120, v121, v122
  v_xor_b32 v120, v200, v145
  v_xor_b32 v121, v201, v147
  v_or3_b32 v122, v120, v121, v122
  v_xor_b32 v120, v202, v149
  v_xor_b32 v121, v203, v151
  v_or3_b32 v122, v120, v121, v122
  v_xor_b32 v120, v204, v153
  v_xor_b32 v121, v205, v155
  v_or3_b32 v122, v120, v121, v122
  v_xor_b32 v120, v206, v157
  v_xor_b32 v121, v207, v159
  v_or3_b32 v122, v120, v121, v122
  v_cmp_ne_u32 vcc, 0, v122
  s_cbranch_vccz Llb_A_10
  buffer_load_dwordx4 v[128:131], v208, s[40:43], 0 offen sc1
  buffer_load_dwordx4 v[132:135], v209, s[40:43], 0 offen sc1
  buffer_load_dwordx4 v[136:139], v210, s[40:43], 0 offen sc1
  buffer_load_dwordx4 v[140:143], v211, s[40:43], 0 offen sc1
  buffer_load_dwordx4 v[144:147], v212, s[40:43], 0 offen sc1
  buffer_load_dwordx4 v[148:151], v213, s[40:43], 0 offen sc1
  buffer_load_dwordx4 v[152:155], v214, s[40:43], 0 offen sc1
  buffer_load_dwordx4 v[156:159], v215, s[40:43], 0 offen sc1
  s_waitcnt vmcnt(8)
  v_xor_b32 v120, v192, v161
  v_xor_b32 v121, v193, v163
  v_or_b32 v122, v120, v121
  v_xor_b32 v120, v194, v165
  v_xor_b32 v121, v195, v167
  v_or3_b32 v122, v120, v121, v122
  v_xor_b32 v120, v196, v169
  v_xor_b32 v121, v197, v171
  v_or3_b32 v122, v120, v121, v122
  v_xor_b32 v120, v198, v173
  v_xor_b32 v121, v199, v175
  v_or3_b32 v122, v120, v121, v122
  v_xor_b32 v120, v200, v177
  v_xor_b32 v121, v201, v179
  v_or3_b32 v122, v120, v121, v122
  v_xor_b32 v120, v202, v181
  v_xor_b32 v121, v203, v183
  v_or3_b32 v122, v120, v121, v122
  v_xor_b32 v120, v204, v185
  v_xor_b32 v121, v205, v187
  v_or3_b32 v122, v120, v121, v122
  v_xor_b32 v120, v206, v189
  v_xor_b32 v121, v207, v191
  v_or3_b32 v122, v120, v121, v122
  v_cmp_ne_u32 vcc, 0, v122
  s_cbranch_vccz Llb_B_11
  buffer_load_dwordx4 v[160:163], v208, s[40:43], 0 offen sc1
  buffer_load_dwordx4 v[164:167], v209, s[40:43], 0 offen sc1
  buffer_load_dwordx4 v[168:171], v210, s[40:43], 0 offen sc1
  buffer_load_dwordx4 v[172:175], v211, s[40:43], 0 offen sc1
  buffer_load_dwordx4 v[176:179], v212, s[40:43], 0 offen sc1
  buffer_load_dwordx4 v[180:183], v213, s[40:43], 0 offen sc1
  buffer_load_dwordx4 v[184:187], v214, s[40:43], 0 offen sc1
  buffer_load_dwordx4 v[188:191], v215, s[40:43], 0 offen sc1
  s_add_u32 s13, s13, 1
  s_cmp_lt_u32 s13, 131072
  s_cbranch_scc1 Llb_9
  s_waitcnt vmcnt(0)
Llb_A_10:
  v_fmac_f32 v152, v94, v156
  v_fmac_f32 v154, v94, v158
  v_fmac_f32 v152, v84, v158
  v_fmac_f32 v154, v95, v156
  v_fmac_f32 v148, v94, v152
  v_fmac_f32 v150, v94, v154
  v_fmac_f32 v148, v84, v154
  v_fmac_f32 v150, v95, v152
  v_fmac_f32 v144, v94, v148
  v_fmac_f32 v146, v94, v150
  v_fmac_f32 v144, v84, v150
  v_fmac_f32 v146, v95, v148
  v_fmac_f32 v140, v94, v144
  v_fmac_f32 v142, v94, v146
  v_fmac_f32 v140, v84, v146
  v_fmac_f32 v142, v95, v144
  v_fmac_f32 v136, v94, v140
  v_fmac_f32 v138, v94, v142
  v_fmac_f32 v136, v84, v142
  v_fmac_f32 v138, v95, v140
  v_fmac_f32 v132, v94, v136
  v_fmac_f32 v134, v94, v138
  v_fmac_f32 v132, v84, v138
  v_fmac_f32 v134, v95, v136
  v_fmac_f32 v128, v94, v132
  v_fmac_f32 v130, v94, v134
  v_fmac_f32 v128, v84, v134
  v_fmac_f32 v130, v95, v132
  v_mov_b32 v120, v128
  v_mov_b32 v121, v130
  s_branch Llb_fin_12
Llb_B_11:
  v_fmac_f32 v184, v94, v188
  v_fmac_f32 v186, v94, v190
  v_fmac_f32 v184, v84, v190
  v_fmac_f32 v186, v95, v188
  v_fmac_f32 v180, v94, v184
  v_fmac_f32 v182, v94, v186
  v_fmac_f32 v180, v84, v186
  v_fmac_f32 v182, v95, v184
  v_fmac_f32 v176, v94, v180
  v_fmac_f32 v178, v94, v182
  v_fmac_f32 v176, v84, v182
  v_fmac_f32 v178, v95, v180
  v_fmac_f32 v172, v94, v176
  v_fmac_f32 v174, v94, v178
  v_fmac_f32 v172, v84, v178
  v_fmac_f32 v174, v95, v176
  v_fmac_f32 v168, v94, v172
  v_fmac_f32 v170, v94, v174
  v_fmac_f32 v168, v84, v174
  v_fmac_f32 v170, v95, v172
  v_fmac_f32 v164, v94, v168
  v_fmac_f32 v166, v94, v170
  v_fmac_f32 v164, v84, v170
  v_fmac_f32 v166, v95, v168
  v_fmac_f32 v160, v94, v164
  v_fmac_f32 v162, v94, v166
  v_fmac_f32 v160, v84, v166
  v_fmac_f32 v162, v95, v164
  v_mov_b32 v120, v160
  v_mov_b32 v121, v162
Llb_fin_12:
  v_pk_mul_f32 v[116:117], v[96:97], v[120:121] op_sel:[0,0] op_sel_hi:[0,1]
  v_pk_fma_f32 v[124:125], v[96:97], v[120:121], v[116:117] op_sel:[1,1,0] op_sel_hi:[1,0,1] neg_lo:[1,0,0]
  ds_write_b64 v2, v[124:125] offset:512
  v_cmp_ne_u32 s[8:9], s76, v218
  v_cmp_ne_u32 s[10:11], s39, v219
  s_or_b64 s[8:9], s[8:9], s[10:11]
  s_cselect_b32 s8, 0, 1
  v_mov_b32 v126, s8
  ds_write_b32 v2, v126 offset:1024
  s_waitcnt lgkmcnt(0)
  s_branch Llb_sk2_13
Llb_skip_8:
  s_cmp_eq_u32 s85, 1
  s_cbranch_scc1 Lc_rest
  s_mov_b32 s13, 0
Lcf2_loop:
  global_load_dwordx4 v[100:103], v15, s[90:91] sc1
  s_add_u32 s13, s13, 1
  s_waitcnt vmcnt(0)
  v_xor_b32 v100, s76, v100
  v_xor_b32 v101, s77, v101
  v_xor_b32 v102, s76, v102
  v_xor_b32 v103, s77, v103
  v_or_b32 v101, v101, v103
  v_or3_b32 v100, v100, v101, v102
  v_cmp_ne_u32 vcc, 0, v100
  s_cbranch_vccz Lcf2_ok
  s_sleep 8
  s_cmp_lt_u32 s13, 131072
  s_cbranch_scc1 Lcf2_loop
Lcf2_ok:
  s_mov_b32 s85, 1
  global_load_dwordx4 v[128:131], v14, s[16:17] offset:0
  global_load_dwordx4 v[132:135], v85, s[16:17] offset:0
  global_load_dwordx4 v[136:139], v14, s[16:17] offset:1024
  global_load_dwordx4 v[140:143], v85, s[16:17] offset:1024
  global_load_dwordx4 v[144:147], v14, s[20:21] offset:0
  global_load_dwordx4 v[148:151], v85, s[20:21] offset:0
  global_load_dwordx4 v[152:155], v14, s[20:21] offset:1024
  global_load_dwordx4 v[156:159], v85, s[20:21] offset:1024
  global_load_dwordx4 v[160:163], v14, s[16:17] offset:2048
  global_load_dwordx4 v[164:167], v85, s[16:17] offset:2048
  global_load_dwordx4 v[168:171], v14, s[16:17] offset:3072
  global_load_dwordx4 v[172:175], v85, s[16:17] offset:3072
  global_load_dwordx4 v[176:179], v14, s[20:21] offset:2048
  global_load_dwordx4 v[180:183], v85, s[20:21] offset:2048
  global_load_dwordx4 v[184:187], v14, s[20:21] offset:3072
  global_load_dwordx4 v[188:191], v85, s[20:21] offset:3072
Lc_rest:
  s_waitcnt vmcnt(14)
  global_load_dwordx4 v[192:195], v14, s[18:19] offset:0
  global_load_dwordx4 v[196:199], v85, s[18:19] offset:0
  s_waitcnt vmcnt(14)
  global_load_dwordx4 v[200:203], v14, s[18:19] offset:1024
  global_load_dwordx4 v[204:207], v85, s[18:19] offset:1024
  s_waitcnt vmcnt(14)
  global_load_dwordx4 v[208:211], v14, s[22:23] offset:0
  global_load_dwordx4 v[212:215], v85, s[22:23] offset:0
  s_waitcnt vmcnt(14)
  global_load_dwordx4 v[216:219], v14, s[22:23] offset:1024
  global_load_dwordx4 v[220:223], v85, s[22:23] offset:1024
  s_waitcnt vmcnt(14)
  global_load_dwordx4 v[224:227], v14, s[18:19] offset:2048
  global_load_dwordx4 v[228:231], v85, s[18:19] offset:2048
  s_waitcnt vmcnt(14)
  global_load_dwordx4 v[232:235], v14, s[18:19] offset:3072
  global_load_dwordx4 v[236:239], v85, s[18:19] offset:3072
  s_waitcnt vmcnt(14)
  global_load_dwordx4 v[240:243], v14, s[22:23] offset:2048
  global_load_dwordx4 v[244:247], v85, s[22:23] offset:2048
  s_waitcnt vmcnt(14)
  global_load_dwordx4 v[248:251], v14, s[22:23] offset:3072
  global_load_dwordx4 v[252:255], v85, s[22:23] offset:3072
Llb_sk2_13:
  s_barrier
  ds_read_b64 v[100:101], v3 offset:512
  ds_read_b64 v[102:103], v3 offset:768
  ds_read_b32 v126, v3 offset:1024
  s_waitcnt lgkmcnt(0)
  v_readfirstlane_b32 s84, v126
  s_cmp_lg_u32 s3, 0
  s_cbranch_scc1 Lw0c
  s_cmp_eq_u32 s85, 0
  s_cbranch_scc1 Lw0c
  global_load_dwordx4 v[128:131], v14, s[16:17] offset:0
  global_load_dwordx4 v[132:135], v85, s[16:17] offset:0
  global_load_dwordx4 v[136:139], v14, s[16:17] offset:1024
  global_load_dwordx4 v[140:143], v85, s[16:17] offset:1024
  global_load_dwordx4 v[144:147], v14, s[20:21] offset:0
  global_load_dwordx4 v[148:151], v85, s[20:21] offset:0
  global_load_dwordx4 v[152:155], v14, s[20:21] offset:1024
  global_load_dwordx4 v[156:159], v85, s[20:21] offset:1024
  global_load_dwordx4 v[160:163], v14, s[16:17] offset:2048
  global_load_dwordx4 v[164:167], v85, s[16:17] offset:2048
  global_load_dwordx4 v[168:171], v14, s[16:17] offset:3072
  global_load_dwordx4 v[172:175], v85, s[16:17] offset:3072
  global_load_dwordx4 v[176:179], v14, s[20:21] offset:2048
  global_load_dwordx4 v[180:183], v85, s[20:21] offset:2048
  global_load_dwordx4 v[184:187], v14, s[20:21] offset:3072
  global_load_dwordx4 v[188:191], v85, s[20:21] offset:3072
  global_load_dwordx4 v[192:195], v14, s[18:19] offset:0
  global_load_dwordx4 v[196:199], v85, s[18:19] offset:0
  global_load_dwordx4 v[200:203], v14, s[18:19] offset:1024
  global_load_dwordx4 v[204:207], v85, s[18:19] offset:1024
  global_load_dwordx4 v[208:211], v14, s[22:23] offset:0
  global_load_dwordx4 v[212:215], v85, s[22:23] offset:0
  global_load_dwordx4 v[216:219], v14, s[22:23] offset:1024
  global_load_dwordx4 v[220:223], v85, s[22:23] offset:1024
  global_load_dwordx4 v[224:227], v14, s[18:19] offset:2048
  global_load_dwordx4 v[228:231], v85, s[18:19] offset:2048
  global_load_dwordx4 v[232:235], v14, s[18:19] offset:3072
  global_load_dwordx4 v[236:239], v85, s[18:19] offset:3072
  global_load_dwordx4 v[240:243], v14, s[22:23] offset:2048
  global_load_dwordx4 v[244:247], v85, s[22:23] offset:2048
  global_load_dwordx4 v[248:251], v14, s[22:23] offset:3072
  global_load_dwordx4 v[252:255], v85, s[22:23] offset:3072
Lw0c:
  v_pk_add_f32 v[100:101], v[100:101], v[102:103]
  v_pk_fma_f32 v[116:117], v[92:93], v[100:101], v[118:119] op_sel:[0,0,0] op_sel_hi:[0,1,1]
  v_pk_fma_f32 v[120:121], v[92:93], v[100:101], v[116:117] op_sel:[1,1,0] op_sel_hi:[1,0,1] neg_lo:[1,0,0]
  v_sub_f32 v122, 0, v120
  v_sub_f32 v123, 0, v121
  v_fmac_f32 v16, v48, v120
  v_fmac_f32 v32, v48, v123
  v_fmac_f32 v16, v49, v123
  v_fmac_f32 v32, v49, v122
  v_fmac_f32 v17, v50, v120
  v_fmac_f32 v33, v50, v123
  v_fmac_f32 v17, v51, v123
  v_fmac_f32 v33, v51, v122
  v_cvt_pk_bf16_f32 v100, v16, v17
  v_cvt_pk_bf16_f32 v108, v32, v33
  v_fmac_f32 v18, v52, v120
  v_fmac_f32 v34, v52, v123
  v_fmac_f32 v18, v53, v123
  v_fmac_f32 v34, v53, v122
  v_fmac_f32 v19, v54, v120
  v_fmac_f32 v35, v54, v123
  v_fmac_f32 v19, v55, v123
  v_fmac_f32 v35, v55, v122
  v_cvt_pk_bf16_f32 v101, v18, v19
  v_cvt_pk_bf16_f32 v109, v34, v35
  v_fmac_f32 v20, v56, v120
  v_fmac_f32 v36, v56, v123
  v_fmac_f32 v20, v57, v123
  v_fmac_f32 v36, v57, v122
  v_fmac_f32 v21, v58, v120
  v_fmac_f32 v37, v58, v123
  v_fmac_f32 v21, v59, v123
  v_fmac_f32 v37, v59, v122
  v_cvt_pk_bf16_f32 v102, v20, v21
  v_cvt_pk_bf16_f32 v110, v36, v37
  v_fmac_f32 v22, v60, v120
  v_fmac_f32 v38, v60, v123
  v_fmac_f32 v22, v61, v123
  v_fmac_f32 v38, v61, v122
  v_fmac_f32 v23, v62, v120
  v_fmac_f32 v39, v62, v123
  v_fmac_f32 v23, v63, v123
  v_fmac_f32 v39, v63, v122
  v_cvt_pk_bf16_f32 v103, v22, v23
  v_cvt_pk_bf16_f32 v111, v38, v39
  ds_write_b128 v9, v[100:103] offset:16384
  ds_write_b128 v9, v[108:111] offset:17408
  v_fmac_f32 v24, v64, v120
  v_fmac_f32 v40, v64, v123
  v_fmac_f32 v24, v65, v123
  v_fmac_f32 v40, v65, v122
  v_fmac_f32 v25, v66, v120
  v_fmac_f32 v41, v66, v123
  v_fmac_f32 v25, v67, v123
  v_fmac_f32 v41, v67, v122
  v_cvt_pk_bf16_f32 v104, v24, v25
  v_cvt_pk_bf16_f32 v112, v40, v41
  v_fmac_f32 v26, v68, v120
  v_fmac_f32 v42, v68, v123
  v_fmac_f32 v26, v69, v123
  v_fmac_f32 v42, v69, v122
  v_fmac_f32 v27, v70, v120
  v_fmac_f32 v43, v70, v123
  v_fmac_f32 v27, v71, v123
  v_fmac_f32 v43, v71, v122
  v_cvt_pk_bf16_f32 v105, v26, v27
  v_cvt_pk_bf16_f32 v113, v42, v43
  v_fmac_f32 v28, v72, v120
  v_fmac_f32 v44, v72, v123
  v_fmac_f32 v28, v73, v123
  v_fmac_f32 v44, v73, v122
  v_fmac_f32 v29, v74, v120
  v_fmac_f32 v45, v74, v123
  v_fmac_f32 v29, v75, v123
  v_fmac_f32 v45, v75, v122
  v_cvt_pk_bf16_f32 v106, v28, v29
  v_cvt_pk_bf16_f32 v114, v44, v45
  v_fmac_f32 v30, v76, v120
  v_fmac_f32 v46, v76, v123
  v_fmac_f32 v30, v77, v123
  v_fmac_f32 v46, v77, v122
  v_fmac_f32 v31, v78, v120
  v_fmac_f32 v47, v78, v123
  v_fmac_f32 v31, v79, v123
  v_fmac_f32 v47, v79, v122
  v_cvt_pk_bf16_f32 v107, v30, v31
  v_cvt_pk_bf16_f32 v115, v46, v47
  ds_write_b128 v9, v[104:107] offset:16400
  ds_write_b128 v9, v[112:115] offset:17424
  ds_read_b64_tr_b16 v[48:49], v10 offset:16384
  ds_read_b64_tr_b16 v[50:51], v10 offset:16512
  ds_read_b64_tr_b16 v[52:53], v10 offset:16896
  ds_read_b64_tr_b16 v[54:55], v10 offset:17024
  ds_read_b64_tr_b16 v[56:57], v10 offset:17408
  ds_read_b64_tr_b16 v[58:59], v10 offset:17536
  ds_read_b64_tr_b16 v[60:61], v10 offset:17920
  ds_read_b64_tr_b16 v[62:63], v10 offset:18048
  s_lshr_b32 s8, s5, 3
  s_lshl_b32 s9, s4, 2
  s_lshl_b32 s8, s8, 1
  s_add_u32 s11, s9, s8
  v_bfe_u32 v4, v1, 2, 1
  v_add_u32 v4, s11, v4
  v_lshlrev_b32 v4, 4, v4
  v_and_b32 v5, 3, v1
  v_add_u32 v4, v4, v5
  v_lshlrev_b32 v4, 3, v4
  s_lshl_b32 s8, s3, 5
  s_add_u32 s8, s8, 135168
  v_add_u32 v4, s8, v4
  s_lshr_b32 s8, s3, 1
  s_add_u32 s10, s11, s8
  s_lshl_b32 s9, s10, 16
  s_lshl_b32 s8, s3, 14
  s_add_u32 s9, s9, s8
  v_lshl_add_u32 v2, v1, 4, s9
  v_xor_b32 v3, 0x10000, v2
  s_lshl_b32 s12, s10, 5
  s_cmp_eq_u32 s84, 0
  s_cbranch_scc1 Lslow_14
  s_waitcnt lgkmcnt(6)
  global_store_dwordx4 v11, v[48:51], s[56:57] offset:0 nt
  s_waitcnt lgkmcnt(4)
  global_store_dwordx4 v11, v[52:55], s[56:57] offset:1024 nt
  s_waitcnt lgkmcnt(2)
  global_store_dwordx4 v11, v[56:59], s[56:57] offset:2048 nt
  s_waitcnt lgkmcnt(0)
  global_store_dwordx4 v11, v[60:63], s[56:57] offset:3072 nt
  s_waitcnt vmcnt(0)
  s_mov_b64 exec, 1
  global_store_dwordx2 v12, v[80:81], s[90:91]
  s_mov_b64 exec, -1
  s_branch Ljoin_15
Lslow_14:
  s_waitcnt lgkmcnt(6)
  global_store_dwordx4 v11, v[48:51], s[56:57] offset:0 sc1
  s_waitcnt lgkmcnt(4)
  global_store_dwordx4 v11, v[52:55], s[56:57] offset:1024 sc1
  s_waitcnt lgkmcnt(2)
  global_store_dwordx4 v11, v[56:59], s[56:57] offset:2048 sc1
  s_waitcnt lgkmcnt(0)
  global_store_dwordx4 v11, v[60:63], s[56:57] offset:3072 sc1
  s_waitcnt vmcnt(0)
  s_mov_b64 exec, 1
  global_store_dwordx2 v12, v[80:81], s[90:91] sc1
  s_mov_b64 exec, -1
Ljoin_15:
  s_cmp_eq_u32 s85, 0
  s_cbranch_scc1 Lc4_18
  s_branch Lc2_16
Lc4_18:
  s_mov_b32 s13, 0
Lcf_loop:
  global_load_dwordx4 v[16:19], v15, s[90:91] sc1
  s_add_u32 s13, s13, 1
  s_waitcnt vmcnt(0)
  v_xor_b32 v16, s76, v16
  v_xor_b32 v17, s77, v17
  v_xor_b32 v18, s76, v18
  v_xor_b32 v19, s77, v19
  v_or_b32 v17, v17, v19
  v_and_b32 v17, -8, v17
  v_or3_b32 v16, v16, v17, v18
  v_cmp_ne_u32 vcc, 0, v16
  s_cbranch_vccz Lc3_17
  s_sleep 8
  s_cmp_lt_u32 s13, 131072
  s_cbranch_scc1 Lcf_loop
Lc3_17:
  global_load_dwordx4 v[128:131], v14, s[16:17] offset:0
  global_load_dwordx4 v[132:135], v85, s[16:17] offset:0
  global_load_dwordx4 v[136:139], v14, s[16:17] offset:1024
  global_load_dwordx4 v[140:143], v85, s[16:17] offset:1024
  global_load_dwordx4 v[144:147], v14, s[20:21] offset:0
  global_load_dwordx4 v[148:151], v85, s[20:21] offset:0
  global_load_dwordx4 v[152:155], v14, s[20:21] offset:1024
  global_load_dwordx4 v[156:159], v85, s[20:21] offset:1024
  global_load_dwordx4 v[160:163], v14, s[16:17] offset:2048
  global_load_dwordx4 v[164:167], v85, s[16:17] offset:2048
  global_load_dwordx4 v[168:171], v14, s[16:17] offset:3072
  global_load_dwordx4 v[172:175], v85, s[16:17] offset:3072
  global_load_dwordx4 v[176:179], v14, s[20:21] offset:2048
  global_load_dwordx4 v[180:183], v85, s[20:21] offset:2048
  global_load_dwordx4 v[184:187], v14, s[20:21] offset:3072
  global_load_dwordx4 v[188:191], v85, s[20:21] offset:3072
  global_load_dwordx4 v[192:195], v14, s[18:19] offset:0
  global_load_dwordx4 v[196:199], v85, s[18:19] offset:0
  global_load_dwordx4 v[200:203], v14, s[18:19] offset:1024
  global_load_dwordx4 v[204:207], v85, s[18:19] offset:1024
  global_load_dwordx4 v[208:211], v14, s[22:23] offset:0
  global_load_dwordx4 v[212:215], v85, s[22:23] offset:0
  global_load_dwordx4 v[216:219], v14, s[22:23] offset:1024
  global_load_dwordx4 v[220:223], v85, s[22:23] offset:1024
  global_load_dwordx4 v[224:227], v14, s[18:19] offset:2048
  global_load_dwordx4 v[228:231], v85, s[18:19] offset:2048
  global_load_dwordx4 v[232:235], v14, s[18:19] offset:3072
  global_load_dwordx4 v[236:239], v85, s[18:19] offset:3072
  global_load_dwordx4 v[240:243], v14, s[22:23] offset:2048
  global_load_dwordx4 v[244:247], v85, s[22:23] offset:2048
  global_load_dwordx4 v[248:251], v14, s[22:23] offset:3072
  global_load_dwordx4 v[252:255], v85, s[22:23] offset:3072
Lc2_16:
  global_load_dwordx2 v[16:17], v4, s[90:91] sc1
  s_add_u32 s16, s56, 0
  s_addc_u32 s17, s57, 0
  s_add_u32 s18, s56, 4096
  s_addc_u32 s19, s57, 0
  s_add_u32 s20, s56, 8192
  s_addc_u32 s21, s57, 0
  s_add_u32 s22, s56, 12288
  s_addc_u32 s23, s57, 0
  s_mov_b32 s24, s52
  s_mov_b32 s25, s53
  s_mov_b32 s26, 8388608
  s_mov_b32 s27, 0x00020000
  s_and_b32 s8, s5, 7
  s_lshl_b32 s8, s8, 1
  s_and_b32 s9, s3, 1
  s_add_u32 s8, s8, s9
  s_lshl_b32 s8, s8, 5
  v_and_b32 v6, 31, v1
  v_add_u32 v6, s8, v6
  v_lshrrev_b32 v7, 5, v1
  v_lshl_add_u32 v7, v7, 2, s12
  v_lshlrev_b32 v8, 1, v6
  v_lshl_add_u32 v9, v7, 10, v8
  v_lshlrev_b32 v6, 2, v6
  v_lshl_add_u32 v6, v7, 12, v6
  s_movk_i32 s28, 0x2000
  s_movk_i32 s29, 0x4000
  s_movk_i32 s30, 0x6000
  s_waitcnt vmcnt(0)
  v_lshlrev_b32 v10, 4, v1
  s_mul_i32 s8, s3, 12288
  s_add_u32 s8, s8, 32768
  v_add_u32 v5, s8, v10
  s_xor_b32 s8, s3, 1
  s_mul_i32 s8, s8, 12288
  s_add_u32 s8, s8, 32768
  v_add_u32 v11, s8, v10
  s_xor_b32 s8, s3, 2
  s_mul_i32 s8, s8, 12288
  s_add_u32 s8, s8, 36864
  v_add_u32 v12, s8, v10
  s_xor_b32 s8, s3, 3
  s_mul_i32 s8, s8, 12288
  s_add_u32 s8, s8, 40960
  v_add_u32 v13, s8, v10
  s_mov_b32 s13, 0
  s_branch Lhf_chk_21
Lhf_19:
  s_sleep 3
  global_load_dwordx2 v[16:17], v4, s[90:91] sc1
  s_add_u32 s13, s13, 1
  s_waitcnt vmcnt(0)
Lhf_chk_21:
  v_cmp_ne_u32 s[8:9], s76, v16
  v_xor_b32 v17, s77, v17
  v_cmp_lt_u32 s[10:11], 7, v17
  s_or_b64 s[8:9], s[8:9], s[10:11]
  s_cbranch_scc0 Lhf_done_20
  s_cmp_lt_u32 s13, 131072
  s_cbranch_scc1 Lhf_19
Lhf_done_20:
  global_load_dwordx4 v[16:19], v3, s[16:17] offset:0 sc1
  global_load_dwordx4 v[20:23], v3, s[16:17] offset:1024 sc1
  global_load_dwordx4 v[24:27], v3, s[16:17] offset:2048 sc1
  global_load_dwordx4 v[28:31], v3, s[16:17] offset:3072 sc1
  global_load_dwordx4 v[32:35], v3, s[18:19] offset:0 sc1
  global_load_dwordx4 v[36:39], v3, s[18:19] offset:1024 sc1
  global_load_dwordx4 v[40:43], v3, s[18:19] offset:2048 sc1
  global_load_dwordx4 v[44:47], v3, s[18:19] offset:3072 sc1
  global_load_dwordx4 v[64:67], v3, s[20:21] offset:0 sc1
  global_load_dwordx4 v[68:71], v3, s[20:21] offset:1024 sc1
  global_load_dwordx4 v[72:75], v3, s[20:21] offset:2048 sc1
  global_load_dwordx4 v[76:79], v3, s[20:21] offset:3072 sc1
  global_load_dwordx4 v[80:83], v3, s[22:23] offset:0 sc1
  global_load_dwordx4 v[84:87], v3, s[22:23] offset:1024 sc1
  global_load_dwordx4 v[88:91], v3, s[22:23] offset:2048 sc1
  global_load_dwordx4 v[92:95], v3, s[22:23] offset:3072 sc1
  global_load_dwordx4 v[48:51], v2, s[16:17] offset:0 sc1
  global_load_dwordx4 v[52:55], v2, s[16:17] offset:1024 sc1
  global_load_dwordx4 v[56:59], v2, s[16:17] offset:2048 sc1
  global_load_dwordx4 v[60:63], v2, s[16:17] offset:3072 sc1
  s_waitcnt vmcnt(19)
  v_mfma_f32_32x32x16_bf16 v[96:111], v[16:19], v[128:131], 0
  v_mfma_f32_32x32x16_bf16 v[112:127], v[16:19], v[132:135], 0
  global_load_dwordx4 v[16:19], v2, s[18:19] offset:0 sc1
  s_waitcnt vmcnt(19)
  v_mfma_f32_32x32x16_bf16 v[96:111], v[20:23], v[136:139], v[96:111]
  v_mfma_f32_32x32x16_bf16 v[112:127], v[20:23], v[140:143], v[112:127]
  global_load_dwordx4 v[20:23], v2, s[18:19] offset:1024 sc1
  s_waitcnt vmcnt(19)
  v_mfma_f32_32x32x16_bf16 v[96:111], v[24:27], v[144:147], v[96:111]
  v_mfma_f32_32x32x16_bf16 v[112:127], v[24:27], v[148:151], v[112:127]
  global_load_dwordx4 v[24:27], v2, s[18:19] offset:2048 sc1
  s_waitcnt vmcnt(19)
  v_mfma_f32_32x32x16_bf16 v[96:111], v[28:31], v[152:155], v[96:111]
  v_mfma_f32_32x32x16_bf16 v[112:127], v[28:31], v[156:159], v[112:127]
  global_load_dwordx4 v[28:31], v2, s[18:19] offset:3072 sc1
  s_waitcnt vmcnt(19)
  v_mfma_f32_32x32x16_bf16 v[96:111], v[32:35], v[160:163], v[96:111]
  v_mfma_f32_32x32x16_bf16 v[112:127], v[32:35], v[164:167], v[112:127]
  global_load_dwordx4 v[32:35], v2, s[20:21] offset:0 sc1
  s_waitcnt vmcnt(19)
  v_mfma_f32_32x32x16_bf16 v[96:111], v[36:39], v[168:171], v[96:111]
  v_mfma_f32_32x32x16_bf16 v[112:127], v[36:39], v[172:175], v[112:127]
  global_load_dwordx4 v[36:39], v2, s[20:21] offset:1024 sc1
  s_waitcnt vmcnt(19)
  v_mfma_f32_32x32x16_bf16 v[96:111], v[40:43], v[176:179], v[96:111]
  v_mfma_f32_32x32x16_bf16 v[112:127], v[40:43], v[180:183], v[112:127]
  global_load_dwordx4 v[40:43], v2, s[20:21] offset:2048 sc1
  s_waitcnt vmcnt(19)
  v_mfma_f32_32x32x16_bf16 v[96:111], v[44:47], v[184:187], v[96:111]
  v_mfma_f32_32x32x16_bf16 v[112:127], v[44:47], v[188:191], v[112:127]
  global_load_dwordx4 v[44:47], v2, s[20:21] offset:3072 sc1
  s_waitcnt vmcnt(19)
  v_mfma_f32_32x32x16_bf16 v[96:111], v[64:67], v[192:195], v[96:111]
  v_mfma_f32_32x32x16_bf16 v[112:127], v[64:67], v[196:199], v[112:127]
  s_waitcnt vmcnt(18)
  v_mfma_f32_32x32x16_bf16 v[96:111], v[68:71], v[200:203], v[96:111]
  v_mfma_f32_32x32x16_bf16 v[112:127], v[68:71], v[204:207], v[112:127]
  s_waitcnt vmcnt(17)
  v_mfma_f32_32x32x16_bf16 v[96:111], v[72:75], v[208:211], v[96:111]
  v_mfma_f32_32x32x16_bf16 v[112:127], v[72:75], v[212:215], v[112:127]
  s_waitcnt vmcnt(16)
  v_mfma_f32_32x32x16_bf16 v[96:111], v[76:79], v[216:219], v[96:111]
  v_mfma_f32_32x32x16_bf16 v[112:127], v[76:79], v[220:223], v[112:127]
  s_waitcnt vmcnt(15)
  v_mfma_f32_32x32x16_bf16 v[96:111], v[80:83], v[224:227], v[96:111]
  v_mfma_f32_32x32x16_bf16 v[112:127], v[80:83], v[228:231], v[112:127]
  s_waitcnt vmcnt(14)
  v_mfma_f32_32x32x16_bf16 v[96:111], v[84:87], v[232:235], v[96:111]
  v_mfma_f32_32x32x16_bf16 v[112:127], v[84:87], v[236:239], v[112:127]
  s_waitcnt vmcnt(13)
  v_mfma_f32_32x32x16_bf16 v[96:111], v[88:91], v[240:243], v[96:111]
  v_mfma_f32_32x32x16_bf16 v[112:127], v[88:91], v[244:247], v[112:127]
  s_waitcnt vmcnt(12)
  v_mfma_f32_32x32x16_bf16 v[96:111], v[92:95], v[248:251], v[96:111]
  v_mfma_f32_32x32x16_bf16 v[112:127], v[92:95], v[252:255], v[112:127]
  s_waitcnt vmcnt(11)
  v_mfma_f32_32x32x16_bf16 v[64:79], v[48:51], v[128:131], 0
  v_mfma_f32_32x32x16_bf16 v[80:95], v[48:51], v[132:135], 0
  global_load_dwordx4 v[48:51], v2, s[22:23] offset:0 sc1
  global_load_dwordx4 v[128:131], v2, s[22:23] offset:1024 sc1
  global_load_dwordx4 v[132:135], v2, s[22:23] offset:2048 sc1
  s_waitcnt vmcnt(13)
  v_mfma_f32_32x32x16_bf16 v[64:79], v[52:55], v[136:139], v[64:79]
  v_mfma_f32_32x32x16_bf16 v[80:95], v[52:55], v[140:143], v[80:95]
  global_load_dwordx4 v[52:55], v2, s[22:23] offset:3072 sc1
  s_waitcnt vmcnt(13)
  v_mfma_f32_32x32x16_bf16 v[64:79], v[56:59], v[144:147], v[64:79]
  v_mfma_f32_32x32x16_bf16 v[80:95], v[56:59], v[148:151], v[80:95]
  s_waitcnt vmcnt(12)
  v_mfma_f32_32x32x16_bf16 v[64:79], v[60:63], v[152:155], v[64:79]
  v_mfma_f32_32x32x16_bf16 v[80:95], v[60:63], v[156:159], v[80:95]
  s_waitcnt vmcnt(11)
  v_mfma_f32_32x32x16_bf16 v[64:79], v[16:19], v[160:163], v[64:79]
  v_mfma_f32_32x32x16_bf16 v[80:95], v[16:19], v[164:167], v[80:95]
  s_waitcnt vmcnt(10)
  v_mfma_f32_32x32x16_bf16 v[64:79], v[20:23], v[168:171], v[64:79]
  v_mfma_f32_32x32x16_bf16 v[80:95], v[20:23], v[172:175], v[80:95]
  buffer_load_ushort v144, v9, s[60:63], 0 offen offset:0
  buffer_load_ushort v145, v9, s[60:63], 0 offen offset:1024
  buffer_load_ushort v146, v9, s[60:63], 0 offen offset:2048
  buffer_load_ushort v147, v9, s[60:63], 0 offen offset:3072
  buffer_load_ushort v148, v9, s[60:63], s28 offen offset:0
  buffer_load_ushort v149, v9, s[60:63], s28 offen offset:1024
  buffer_load_ushort v150, v9, s[60:63], s28 offen offset:2048
  buffer_load_ushort v151, v9, s[60:63], s28 offen offset:3072
  buffer_load_ushort v152, v9, s[60:63], s29 offen offset:0
  buffer_load_ushort v153, v9, s[60:63], s29 offen offset:1024
  buffer_load_ushort v154, v9, s[60:63], s29 offen offset:2048
  buffer_load_ushort v155, v9, s[60:63], s29 offen offset:3072
  buffer_load_ushort v156, v9, s[60:63], s30 offen offset:0
  buffer_load_ushort v157, v9, s[60:63], s30 offen offset:1024
  buffer_load_ushort v158, v9, s[60:63], s30 offen offset:2048
  buffer_load_ushort v159, v9, s[60:63], s30 offen offset:3072
  global_load_ushort v160, v8, s[32:33]
  s_waitcnt vmcnt(26)
  v_mfma_f32_32x32x16_bf16 v[64:79], v[24:27], v[176:179], v[64:79]
  ds_write_b128 v12, v[96:99] offset:0
  v_mfma_f32_32x32x16_bf16 v[80:95], v[24:27], v[180:183], v[80:95]
  ds_write_b128 v12, v[100:103] offset:1024
  s_waitcnt vmcnt(25)
  v_mfma_f32_32x32x16_bf16 v[64:79], v[28:31], v[184:187], v[64:79]
  ds_write_b128 v12, v[104:107] offset:2048
  v_mfma_f32_32x32x16_bf16 v[80:95], v[28:31], v[188:191], v[80:95]
  ds_write_b128 v12, v[108:111] offset:3072
  s_waitcnt vmcnt(24)
  v_mfma_f32_32x32x16_bf16 v[64:79], v[32:35], v[192:195], v[64:79]
  ds_write_b128 v13, v[112:115] offset:0
  v_mfma_f32_32x32x16_bf16 v[80:95], v[32:35], v[196:199], v[80:95]
  ds_write_b128 v13, v[116:119] offset:1024
  s_waitcnt vmcnt(23)
  v_mfma_f32_32x32x16_bf16 v[64:79], v[36:39], v[200:203], v[64:79]
  ds_write_b128 v13, v[120:123] offset:2048
  v_mfma_f32_32x32x16_bf16 v[80:95], v[36:39], v[204:207], v[80:95]
  ds_write_b128 v13, v[124:127] offset:3072
  s_waitcnt vmcnt(22)
  v_mfma_f32_32x32x16_bf16 v[64:79], v[40:43], v[208:211], v[64:79]
  v_mfma_f32_32x32x16_bf16 v[80:95], v[40:43], v[212:215], v[80:95]
  s_waitcnt vmcnt(21)
  v_mfma_f32_32x32x16_bf16 v[64:79], v[44:47], v[216:219], v[64:79]
  v_mfma_f32_32x32x16_bf16 v[80:95], v[44:47], v[220:223], v[80:95]
  s_waitcnt vmcnt(20)
  v_mfma_f32_32x32x16_bf16 v[64:79], v[48:51], v[224:227], v[64:79]
  v_mfma_f32_32x32x16_bf16 v[80:95], v[48:51], v[228:231], v[80:95]
  s_waitcnt vmcnt(19)
  v_mfma_f32_32x32x16_bf16 v[64:79], v[128:131], v[232:235], v[64:79]
  v_mfma_f32_32x32x16_bf16 v[80:95], v[128:131], v[236:239], v[80:95]
  s_waitcnt vmcnt(18)
  v_mfma_f32_32x32x16_bf16 v[64:79], v[132:135], v[240:243], v[64:79]
  v_mfma_f32_32x32x16_bf16 v[80:95], v[132:135], v[244:247], v[80:95]
  s_waitcnt vmcnt(17)
  v_mfma_f32_32x32x16_bf16 v[64:79], v[52:55], v[248:251], v[64:79]
  v_mfma_f32_32x32x16_bf16 v[80:95], v[52:55], v[252:255], v[80:95]
  s_waitcnt vmcnt(0)
  v_lshlrev_b32 v160, 16, v160
  v_lshlrev_b32 v144, 16, v144
  v_lshlrev_b32 v145, 16, v145
  v_mul_f32 v144, v144, v160
  v_mul_f32 v145, v145, v160
  v_cvt_pk_bf16_f32 v144, v144, v145
  v_and_b32 v145, 0xffff0000, v144
  v_lshlrev_b32 v144, 16, v144
  v_lshlrev_b32 v146, 16, v146
  v_lshlrev_b32 v147, 16, v147
  v_mul_f32 v146, v146, v160
  v_mul_f32 v147, v147, v160
  v_cvt_pk_bf16_f32 v146, v146, v147
  v_and_b32 v147, 0xffff0000, v146
  v_lshlrev_b32 v146, 16, v146
  ds_write_b128 v11, v[80:83] offset:0
  ds_write_b128 v11, v[84:87] offset:1024
  ds_write_b128 v11, v[88:91] offset:2048
  ds_write_b128 v11, v[92:95] offset:3072
  v_lshlrev_b32 v148, 16, v148
  v_lshlrev_b32 v149, 16, v149
  v_mul_f32 v148, v148, v160
  v_mul_f32 v149, v149, v160
  v_cvt_pk_bf16_f32 v148, v148, v149
  v_and_b32 v149, 0xffff0000, v148
  v_lshlrev_b32 v148, 16, v148
  v_lshlrev_b32 v150, 16, v150
  v_lshlrev_b32 v151, 16, v151
  v_mul_f32 v150, v150, v160
  v_mul_f32 v151, v151, v160
  v_cvt_pk_bf16_f32 v150, v150, v151
  v_and_b32 v151, 0xffff0000, v150
  v_lshlrev_b32 v150, 16, v150
  v_lshlrev_b32 v152, 16, v152
  v_lshlrev_b32 v153, 16, v153
  v_mul_f32 v152, v152, v160
  v_mul_f32 v153, v153, v160
  v_cvt_pk_bf16_f32 v152, v152, v153
  v_and_b32 v153, 0xffff0000, v152
  v_lshlrev_b32 v152, 16, v152
  v_lshlrev_b32 v154, 16, v154
  v_lshlrev_b32 v155, 16, v155
  v_mul_f32 v154, v154, v160
  v_mul_f32 v155, v155, v160
  v_cvt_pk_bf16_f32 v154, v154, v155
  v_and_b32 v155, 0xffff0000, v154
  v_lshlrev_b32 v154, 16, v154
  v_lshlrev_b32 v156, 16, v156
  v_lshlrev_b32 v157, 16, v157
  v_mul_f32 v156, v156, v160
  v_mul_f32 v157, v157, v160
  v_cvt_pk_bf16_f32 v156, v156, v157
  v_and_b32 v157, 0xffff0000, v156
  v_lshlrev_b32 v156, 16, v156
  v_lshlrev_b32 v158, 16, v158
  v_lshlrev_b32 v159, 16, v159
  v_mul_f32 v158, v158, v160
  v_mul_f32 v159, v159, v160
  v_cvt_pk_bf16_f32 v158, v158, v159
  v_and_b32 v159, 0xffff0000, v158
  v_lshlrev_b32 v158, 16, v158
  v_pk_add_f32 v[64:65], v[64:65], v[144:145]
  v_pk_add_f32 v[66:67], v[66:67], v[146:147]
  v_pk_add_f32 v[68:69], v[68:69], v[148:149]
  v_pk_add_f32 v[70:71], v[70:71], v[150:151]
  v_pk_add_f32 v[72:73], v[72:73], v[152:153]
  v_pk_add_f32 v[74:75], v[74:75], v[154:155]
  v_pk_add_f32 v[76:77], v[76:77], v[156:157]
  v_pk_add_f32 v[78:79], v[78:79], v[158:159]
  s_waitcnt lgkmcnt(0)
  s_barrier
  ds_read_b128 v[16:19], v5 offset:0
  ds_read_b128 v[32:35], v5 offset:4096
  ds_read_b128 v[48:51], v5 offset:8192
  ds_read_b128 v[20:23], v5 offset:1024
  ds_read_b128 v[36:39], v5 offset:5120
  ds_read_b128 v[52:55], v5 offset:9216
  ds_read_b128 v[24:27], v5 offset:2048
  ds_read_b128 v[40:43], v5 offset:6144
  ds_read_b128 v[56:59], v5 offset:10240
  ds_read_b128 v[28:31], v5 offset:3072
  ds_read_b128 v[44:47], v5 offset:7168
  ds_read_b128 v[60:63], v5 offset:11264
  s_waitcnt lgkmcnt(9)
  v_pk_add_f32 v[16:17], v[16:17], v[32:33]
  v_pk_add_f32 v[64:65], v[64:65], v[48:49]
  v_pk_add_f32 v[64:65], v[64:65], v[16:17]
  v_pk_add_f32 v[18:19], v[18:19], v[34:35]
  v_pk_add_f32 v[66:67], v[66:67], v[50:51]
  v_pk_add_f32 v[66:67], v[66:67], v[18:19]
  s_mov_b32 s8, 0
  buffer_store_dword v64, v6, s[24:27], s8 offen nt
  s_mov_b32 s8, 4096
  buffer_store_dword v65, v6, s[24:27], s8 offen nt
  s_mov_b32 s8, 8192
  buffer_store_dword v66, v6, s[24:27], s8 offen nt
  s_mov_b32 s8, 12288
  buffer_store_dword v67, v6, s[24:27], s8 offen nt
  s_waitcnt lgkmcnt(6)
  v_pk_add_f32 v[20:21], v[20:21], v[36:37]
  v_pk_add_f32 v[68:69], v[68:69], v[52:53]
  v_pk_add_f32 v[68:69], v[68:69], v[20:21]
  v_pk_add_f32 v[22:23], v[22:23], v[38:39]
  v_pk_add_f32 v[70:71], v[70:71], v[54:55]
  v_pk_add_f32 v[70:71], v[70:71], v[22:23]
  s_mov_b32 s8, 32768
  buffer_store_dword v68, v6, s[24:27], s8 offen nt
  s_mov_b32 s8, 36864
  buffer_store_dword v69, v6, s[24:27], s8 offen nt
  s_mov_b32 s8, 40960
  buffer_store_dword v70, v6, s[24:27], s8 offen nt
  s_mov_b32 s8, 45056
  buffer_store_dword v71, v6, s[24:27], s8 offen nt
  s_waitcnt lgkmcnt(3)
  v_pk_add_f32 v[24:25], v[24:25], v[40:41]
  v_pk_add_f32 v[72:73], v[72:73], v[56:57]
  v_pk_add_f32 v[72:73], v[72:73], v[24:25]
  v_pk_add_f32 v[26:27], v[26:27], v[42:43]
  v_pk_add_f32 v[74:75], v[74:75], v[58:59]
  v_pk_add_f32 v[74:75], v[74:75], v[26:27]
  s_mov_b32 s8, 65536
  buffer_store_dword v72, v6, s[24:27], s8 offen nt
  s_mov_b32 s8, 69632
  buffer_store_dword v73, v6, s[24:27], s8 offen nt
  s_mov_b32 s8, 73728
  buffer_store_dword v74, v6, s[24:27], s8 offen nt
  s_mov_b32 s8, 77824
  buffer_store_dword v75, v6, s[24:27], s8 offen nt
  s_waitcnt lgkmcnt(0)
  v_pk_add_f32 v[28:29], v[28:29], v[44:45]
  v_pk_add_f32 v[76:77], v[76:77], v[60:61]
  v_pk_add_f32 v[76:77], v[76:77], v[28:29]
  v_pk_add_f32 v[30:31], v[30:31], v[46:47]
  v_pk_add_f32 v[78:79], v[78:79], v[62:63]
  v_pk_add_f32 v[78:79], v[78:79], v[30:31]
  s_mov_b32 s8, 98304
  buffer_store_dword v76, v6, s[24:27], s8 offen nt
  s_mov_b32 s8, 102400
  buffer_store_dword v77, v6, s[24:27], s8 offen nt
  s_mov_b32 s8, 106496
  buffer_store_dword v78, v6, s[24:27], s8 offen nt
  s_mov_b32 s8, 110592
  buffer_store_dword v79, v6, s[24:27], s8 offen nt
WARMEND_A:
  s_endpgm
L_typeB:
  s_getpc_b64 s[8:9]
L_pcB:
  s_mul_i32 s10, s3, WSH_B
  v_lshlrev_b32 v3, 7, v1
  v_min_u32 v3, WSH_B, v3
  v_add_u32 v3, s10, v3
  global_load_dword v255, v3, s[8:9]
  s_and_b32 s4, s7, 31
  s_lshr_b32 s5, s3, 1
  s_and_b32 s12, s3, 1
  s_lshl_b32 s8, s6, 6
  s_lshl_b32 s9, s4, 1
  s_add_u32 s8, s8, s9
  s_add_u32 s60, s8, s5
  s_mul_i32 s61, s5, 31008
  s_mul_i32 s62, s5, 3072
  s_add_u32 s62, s62, 62016
  s_mul_i32 s63, s5, 16640
  s_mul_i32 s64, s5, 4608
  s_add_u32 s64, s64, 33280
  v_mov_b32 v2, 0
  v_lshrrev_b32 v42, 3, v0
  v_and_b32 v43, 7, v0
  v_lshlrev_b32 v43, 4, v43
  v_lshl_add_u32 v42, v42, 10, v43
  s_lshl_b32 s8, s4, 16
  s_lshl_b32 s9, s6, 7
  s_add_u32 s8, s8, s9
  v_add_u32 v42, s8, v42
  v_add_u32 v43, 32768, v42
  s_lshl_b32 s8, s60, 8
  s_lshl_b32 s9, s12, 7
  s_add_u32 s8, s8, s9
  v_lshl_add_u32 v44, v1, 1, s8
  s_lshl_b32 s8, s60, 1
  v_mov_b32 v45, s8
  s_lshl_b32 s8, s4, 6
  s_lshl_b32 s9, s3, 4
  s_add_u32 s8, s8, s9
  s_lshl_b32 s9, s6, 6
  v_add_u32 v47, s9, v1
  v_lshlrev_b32 v247, 1, v47
  s_lshl_b32 s9, s3, 11
  s_add_u32 s9, s9, 68160
  v_lshl_add_u32 v248, v1, 1, s9
  s_lshl_b32 s9, s8, 12
  s_add_u32 s9, s9, 2048
  v_lshl_add_u32 v46, v47, 2, s9
  s_getreg_b32 s72, hwreg(HW_REG_XCC_ID)
  s_and_b32 s72, s72, 7
  s_mov_b32 s82, 8388608
  s_mov_b32 s83, 0x00020000
  s_mov_b32 s86, 2097152
  s_mov_b32 s87, 0x00020000
  s_waitcnt lgkmcnt(0)
  s_mov_b32 s84, s34
  s_mov_b32 s85, s35
  v_mov_b32 v241, v42
  v_mov_b32 v242, v43
  global_load_ushort v12, v44, s[36:37] nt
  global_load_ushort v13, v44, s[38:39] nt
  global_load_ushort v14, v44, s[40:41] nt
  global_load_ushort v15, v44, s[42:43] nt
  global_load_ushort v16, v44, s[44:45] nt
  global_load_ushort v17, v44, s[46:47] nt
  global_load_ushort v18, v45, s[48:49]
  v_mov_b32 v2, 8548352
  global_load_dwordx2 v[250:251], v2, s[56:57]
  global_load_ushort v252, v247, s[50:51]
  s_mov_b32 s80, s52
  s_mov_b32 s81, s53
  s_add_u32 s66, s56, 8388608
  s_addc_u32 s67, s57, 0
  s_add_u32 s70, s56, 4194304
  s_addc_u32 s71, s57, 0
  s_add_u32 s44, s56, 4194304
  s_addc_u32 s45, s57, 0
  s_add_u32 s46, s56, 4227072
  s_addc_u32 s47, s57, 0
  s_add_u32 s48, s56, 4259840
  s_addc_u32 s49, s57, 0
  s_add_u32 s50, s56, 4292608
  s_addc_u32 s51, s57, 0
  s_add_u32 s16, s56, 4194304
  s_addc_u32 s17, s57, 0
  s_add_u32 s18, s56, 4198400
  s_addc_u32 s19, s57, 0
  s_add_u32 s20, s56, 4202496
  s_addc_u32 s21, s57, 0
  s_add_u32 s22, s56, 4206592
  s_addc_u32 s23, s57, 0
  s_lshl_b32 s8, s12, 10
  s_sub_u32 s8, 2040, s8
  v_lshlrev_b32 v76, 3, v1
  v_sub_u32 v76, s8, v76
  s_sub_u32 s9, s62, 68096
  v_add_u32 v77, 0, v76
  v_add_u32 v78, -512, v76
  v_cvt_f32_u32 v79, v77
  v_cvt_f32_u32 v80, v78
  v_cvt_pk_bf16_f32 v79, v79, v80
  v_min_u32 v77, 128, v77
  v_min_u32 v78, 128, v78
  v_add_u32 v77, 17024, v77
  v_add_u32 v78, 17024, v78
  v_lshrrev_b32 v80, 16, v79
  v_and_b32 v79, 0xffff, v79
  v_max_u32 v77, v77, v79
  v_max_u32 v78, v78, v80
  v_lshl_add_u32 v20, v77, 2, s9
  v_lshl_add_u32 v31, v78, 2, s9
  v_add_u32 v77, 1, v76
  v_add_u32 v78, -511, v76
  v_cvt_f32_u32 v79, v77
  v_cvt_f32_u32 v80, v78
  v_cvt_pk_bf16_f32 v79, v79, v80
  v_min_u32 v77, 128, v77
  v_min_u32 v78, 128, v78
  v_add_u32 v77, 17024, v77
  v_add_u32 v78, 17024, v78
  v_lshrrev_b32 v80, 16, v79
  v_and_b32 v79, 0xffff, v79
  v_max_u32 v77, v77, v79
  v_max_u32 v78, v78, v80
  v_lshl_add_u32 v21, v77, 2, s9
  v_lshl_add_u32 v32, v78, 2, s9
  v_add_u32 v77, 2, v76
  v_add_u32 v78, -510, v76
  v_cvt_f32_u32 v79, v77
  v_cvt_f32_u32 v80, v78
  v_cvt_pk_bf16_f32 v79, v79, v80
  v_min_u32 v77, 128, v77
  v_min_u32 v78, 128, v78
  v_add_u32 v77, 17024, v77
  v_add_u32 v78, 17024, v78
  v_lshrrev_b32 v80, 16, v79
  v_and_b32 v79, 0xffff, v79
  v_max_u32 v77, v77, v79
  v_max_u32 v78, v78, v80
  v_lshl_add_u32 v22, v77, 2, s9
  v_lshl_add_u32 v33, v78, 2, s9
  v_add_u32 v77, 3, v76
  v_add_u32 v78, -509, v76
  v_cvt_f32_u32 v79, v77
  v_cvt_f32_u32 v80, v78
  v_cvt_pk_bf16_f32 v79, v79, v80
  v_min_u32 v77, 128, v77
  v_min_u32 v78, 128, v78
  v_add_u32 v77, 17024, v77
  v_add_u32 v78, 17024, v78
  v_lshrrev_b32 v80, 16, v79
  v_and_b32 v79, 0xffff, v79
  v_max_u32 v77, v77, v79
  v_max_u32 v78, v78, v80
  v_lshl_add_u32 v23, v77, 2, s9
  v_lshl_add_u32 v34, v78, 2, s9
  v_add_u32 v77, 4, v76
  v_add_u32 v78, -508, v76
  v_cvt_f32_u32 v79, v77
  v_cvt_f32_u32 v80, v78
  v_cvt_pk_bf16_f32 v79, v79, v80
  v_min_u32 v77, 128, v77
  v_min_u32 v78, 128, v78
  v_add_u32 v77, 17024, v77
  v_add_u32 v78, 17024, v78
  v_lshrrev_b32 v80, 16, v79
  v_and_b32 v79, 0xffff, v79
  v_max_u32 v77, v77, v79
  v_max_u32 v78, v78, v80
  v_lshl_add_u32 v24, v77, 2, s9
  v_lshl_add_u32 v35, v78, 2, s9
  v_add_u32 v77, 5, v76
  v_add_u32 v78, -507, v76
  v_cvt_f32_u32 v79, v77
  v_cvt_f32_u32 v80, v78
  v_cvt_pk_bf16_f32 v79, v79, v80
  v_min_u32 v77, 128, v77
  v_min_u32 v78, 128, v78
  v_add_u32 v77, 17024, v77
  v_add_u32 v78, 17024, v78
  v_lshrrev_b32 v80, 16, v79
  v_and_b32 v79, 0xffff, v79
  v_max_u32 v77, v77, v79
  v_max_u32 v78, v78, v80
  v_lshl_add_u32 v25, v77, 2, s9
  v_lshl_add_u32 v36, v78, 2, s9
  v_add_u32 v77, 6, v76
  v_add_u32 v78, -506, v76
  v_cvt_f32_u32 v79, v77
  v_cvt_f32_u32 v80, v78
  v_cvt_pk_bf16_f32 v79, v79, v80
  v_min_u32 v77, 128, v77
  v_min_u32 v78, 128, v78
  v_add_u32 v77, 17024, v77
  v_add_u32 v78, 17024, v78
  v_lshrrev_b32 v80, 16, v79
  v_and_b32 v79, 0xffff, v79
  v_max_u32 v77, v77, v79
  v_max_u32 v78, v78, v80
  v_lshl_add_u32 v26, v77, 2, s9
  v_lshl_add_u32 v37, v78, 2, s9
  v_add_u32 v77, 7, v76
  v_add_u32 v78, -505, v76
  v_cvt_f32_u32 v79, v77
  v_cvt_f32_u32 v80, v78
  v_cvt_pk_bf16_f32 v79, v79, v80
  v_min_u32 v77, 128, v77
  v_min_u32 v78, 128, v78
  v_add_u32 v77, 17024, v77
  v_add_u32 v78, 17024, v78
  v_lshrrev_b32 v80, 16, v79
  v_and_b32 v79, 0xffff, v79
  v_max_u32 v77, v77, v79
  v_max_u32 v78, v78, v80
  v_lshl_add_u32 v27, v77, 2, s9
  v_lshl_add_u32 v38, v78, 2, s9
  v_add_u32 v77, 8, v76
  v_add_u32 v78, -504, v76
  v_cvt_f32_u32 v79, v77
  v_cvt_f32_u32 v80, v78
  v_cvt_pk_bf16_f32 v79, v79, v80
  v_min_u32 v77, 128, v77
  v_min_u32 v78, 128, v78
  v_add_u32 v77, 17024, v77
  v_add_u32 v78, 17024, v78
  v_lshrrev_b32 v80, 16, v79
  v_and_b32 v79, 0xffff, v79
  v_max_u32 v77, v77, v79
  v_max_u32 v78, v78, v80
  v_lshl_add_u32 v28, v77, 2, s9
  v_lshl_add_u32 v39, v78, 2, s9
  v_add_u32 v77, 9, v76
  v_add_u32 v78, -503, v76
  v_cvt_f32_u32 v79, v77
  v_cvt_f32_u32 v80, v78
  v_cvt_pk_bf16_f32 v79, v79, v80
  v_min_u32 v77, 128, v77
  v_min_u32 v78, 128, v78
  v_add_u32 v77, 17024, v77
  v_add_u32 v78, 17024, v78
  v_lshrrev_b32 v80, 16, v79
  v_and_b32 v79, 0xffff, v79
  v_max_u32 v77, v77, v79
  v_max_u32 v78, v78, v80
  v_lshl_add_u32 v29, v77, 2, s9
  v_lshl_add_u32 v40, v78, 2, s9
  v_add_u32 v77, 10, v76
  v_add_u32 v78, -502, v76
  v_cvt_f32_u32 v79, v77
  v_cvt_f32_u32 v80, v78
  v_cvt_pk_bf16_f32 v79, v79, v80
  v_min_u32 v77, 128, v77
  v_min_u32 v78, 128, v78
  v_add_u32 v77, 17024, v77
  v_add_u32 v78, 17024, v78
  v_lshrrev_b32 v80, 16, v79
  v_and_b32 v79, 0xffff, v79
  v_max_u32 v77, v77, v79
  v_max_u32 v78, v78, v80
  v_lshl_add_u32 v30, v77, 2, s9
  v_lshl_add_u32 v41, v78, 2, s9
  s_lshl_b32 s9, s6, 8
  s_lshl_b32 s10, s4, 3
  s_add_u32 s9, s9, s10
  s_add_u32 s9, s9, 151552
  v_mov_b32 v245, s9
  v_lshrrev_b32 v76, 4, v1
  v_bfe_u32 v77, v1, 2, 2
  v_and_b32 v78, 3, v1
  v_and_b32 v79, 15, v1
  v_lshlrev_b32 v80, 4, v76
  v_lshl_add_u32 v80, v78, 2, v80
  v_add_u32 v80, v80, v77
  v_lshlrev_b32 v80, 7, v80
  s_lshl_b32 s8, s3, 5
  s_add_u32 s8, s8, 68160
  v_add_u32 v43, s8, v80
  s_lshl_b32 s8, s6, 2
  s_add_u32 s8, s8, s3
  s_lshl_b32 s8, s8, 17
  s_lshl_b32 s9, s4, 9
  s_add_u32 s8, s8, s9
  v_lshrrev_b32 v80, 2, v1
  v_lshlrev_b32 v80, 5, v80
  v_and_b32 v81, 1, v1
  v_lshl_add_u32 v80, v81, 4, v80
  v_bfe_u32 v81, v1, 1, 1
  v_lshl_add_u32 v80, v81, 14, v80
  v_add_u32 v44, s8, v80
  s_lshl_b32 s8, s12, 8
  s_add_u32 s8, s8, s61
  v_lshl_add_u32 v45, v1, 2, s8
  s_movk_i32 s8, 544
  v_mul_lo_u32 v80, v79, s8
  v_lshl_add_u32 v80, v76, 4, v80
  v_add_u32 v48, s61, v80
  s_mul_i32 s8, s12, 8704
  v_add_u32 v49, s8, v48
  v_lshl_add_u32 v80, v76, 6, v79
  v_lshlrev_b32 v80, 2, v80
  s_add_u32 s8, s62, 2048
  v_add_u32 v50, s8, v80
  v_lshrrev_b32 v80, 1, v76
  v_lshlrev_b32 v80, 7, v80
  v_lshl_add_u32 v80, v79, 3, v80
  v_and_b32 v81, 1, v76
  v_lshl_add_u32 v80, v81, 2, v80
  v_lshlrev_b32 v81, 6, v76
  v_add_u32 v81, 256, v81
  v_lshl_add_u32 v82, v79, 2, v81
  v_lshl_add_u32 v83, v79, 1, v81
  v_cmp_gt_u32 vcc, 2, v76
  v_mov_b32 v84, 32
  s_nop 0
  v_cndmask_b32 v82, v83, v82, vcc
  v_cndmask_b32 v84, v84, 2, vcc
  s_cmp_eq_u32 s12, 0
  s_cselect_b64 vcc, -1, 0
  v_cndmask_b32 v82, v82, v80, vcc
  v_cndmask_b32 v84, v84, 2, vcc
  v_lshl_add_u32 v51, v82, 2, s62
  v_lshl_add_u32 v52, v84, 2, v51
  s_lshl_b32 s8, s12, 11
  s_add_u32 s8, s8, s63
  v_lshl_add_u32 v53, v1, 4, s8
  v_add_u32 v80, 1, v79
  v_and_b32 v80, 3, v80
  s_movk_i32 s8, 4162
  v_mul_lo_u32 v80, v80, s8
  v_lshl_add_u32 v80, v76, 4, v80
  v_lshlrev_b32 v81, 1, v79
  v_sub_u32 v80, v80, v81
  s_lshl_b32 s8, s12, 8
  s_sub_u32 s9, s63, s8
  s_add_u32 s9, s9, 286
  v_add_u32 v54, s9, v80
  v_lshlrev_b32 v80, 5, v79
  v_lshl_add_u32 v80, v76, 4, v80
  s_sub_u32 s9, s64, s8
  s_add_u32 s9, s9, 288
  v_add_u32 v55, s9, v80
  s_lshl_b32 s8, s60, 13
  s_lshl_b32 s9, s12, 12
  s_add_u32 s8, s8, s9
  v_lshl_add_u32 v56, v1, 4, s8
  s_lshl_b32 s8, s6, 5
  s_add_u32 s8, s8, s4
  s_lshl_b32 s8, s8, 14
  v_lshrrev_b32 v80, 1, v0
  v_and_b32 v81, 1, v0
  v_lshl_add_u32 v57, v0, 4, s8
  v_mul_u32_u24 v81, 4608, v81
  v_lshl_add_u32 v81, v80, 3, v81
  v_add_u32 v58, 33792, v81
  s_lshl_b32 s8, s6, 2
  s_add_u32 s8, s8, s3
  s_lshl_b32 s8, s8, 17
  s_lshr_b32 s9, s4, 2
  s_lshl_b32 s9, s9, 10
  s_add_u32 s8, s8, s9
  s_and_b32 s9, s4, 3
  s_lshl_b32 s9, s9, 6
  s_add_u32 s8, s8, s9
  v_lshrrev_b32 v80, 2, v1
  v_lshlrev_b32 v81, 13, v80
  v_lshl_add_u32 v81, v78, 4, v81
  v_add_u32 v47, s8, v81
  s_lshl_b32 s8, s3, 4
  v_add_u32 v80, s8, v80
  v_mul_u32_u24 v80, 144, v80
  v_lshl_add_u32 v59, v78, 5, v80
  v_mul_u32_u24 v80, 144, v1
  s_lshl_b32 s8, s3, 5
  v_add_u32 v3, s8, v80
  s_lshl_b32 s8, s3, 10
  s_add_u32 m0, s8, 68160
  s_add_u32 s9, s8, 72256
  buffer_load_dwordx4 v241, s[84:87], 0 offen nt lds
  s_mov_b32 m0, s9
  s_nop 0
  buffer_load_dwordx4 v242, s[84:87], 0 offen nt lds
  s_waitcnt vmcnt(2)
  v_readfirstlane_b32 s76, v250
  v_readfirstlane_b32 s77, v251
  s_add_u32 s76, s76, 0x9e3779b9
  s_mul_i32 s77, s77, 0x85ebca6b
  s_add_u32 s77, s77, 0x7f4a7c18
  s_mov_b32 s75, s76
  s_xor_b32 s74, s77, s72
  v_mov_b32 v196, s76
  v_mov_b32 v197, s74
  v_lshlrev_b32 v12, 16, v12
  v_lshlrev_b32 v13, 16, v13
  v_lshlrev_b32 v14, 16, v14
  v_lshlrev_b32 v15, 16, v15
  v_lshlrev_b32 v16, 16, v16
  v_lshlrev_b32 v17, 16, v17
  v_lshlrev_b32 v18, 16, v18
  v_mul_f32 v79, 0x3fb8aa3b, v18
  v_exp_f32 v79, v79
  s_nop 0
  v_cvt_pk_bf16_f32 v79, v79, v79
  v_lshlrev_b32 v79, 16, v79
  v_mul_f32 v76, v79, v12
  v_mul_f32 v77, v79, v13
  v_mul_f32 v76, 0x3fb8aa3b, v76
  v_mul_f32 v77, 0x3e22f983, v77
  v_sub_f32 v78, 0, v77
  v_mul_f32 v14, v79, v14
  v_mul_f32 v15, v79, v15
  v_mul_f32 v84, v16, v14
  v_fma_f32 v84, -v17, v15, v84
  v_mul_f32 v85, v16, v15
  v_fma_f32 v85, -v17, v14, -v85
  v_mul_f32 v90, 1.0, v76
  v_mul_f32 v91, 1.0, v77
  v_exp_f32 v90, v90
  v_fract_f32 v91, v91
  v_cos_f32 v94, v91
  v_sin_f32 v95, v91
  v_mul_f32 v94, v90, v94
  v_mul_f32 v95, v90, v95
  v_mul_f32 v90, 0x41000000, v76
  v_mul_f32 v91, 0x41000000, v78
  v_exp_f32 v90, v90
  v_fract_f32 v91, v91
  v_cos_f32 v80, v91
  v_sin_f32 v81, v91
  v_mul_f32 v80, v90, v80
  v_mul_f32 v81, v90, v81
  v_mul_f32 v90, 0x43000000, v76
  v_mul_f32 v91, 0x43000000, v77
  v_exp_f32 v90, v90
  v_fract_f32 v91, v91
  v_cos_f32 v82, v91
  v_sin_f32 v83, v91
  v_mul_f32 v82, v90, v82
  v_mul_f32 v83, v90, v83
  v_mov_b32 v112, 0x3f80
  v_cvt_pk_bf16_f32 v113, v94, v95
  v_pk_mul_f32 v[90:91], v[94:95], v[94:95] op_sel:[0,0] op_sel_hi:[0,1]
  v_pk_fma_f32 v[96:97], v[94:95], v[94:95], v[90:91] op_sel:[1,1,0] op_sel_hi:[1,0,1] neg_lo:[1,0,0]
  v_cvt_pk_bf16_f32 v114, v96, v97
  v_cvt_pk_bf16_f32 v153, v84, v85
  v_pk_mul_f32 v[92:93], v[84:85], v[80:81] op_sel:[0,0] op_sel_hi:[0,1]
  v_pk_fma_f32 v[84:85], v[84:85], v[80:81], v[92:93] op_sel:[1,1,0] op_sel_hi:[1,0,1] neg_lo:[1,0,0]
  v_pk_mul_f32 v[90:91], v[96:97], v[94:95] op_sel:[0,0] op_sel_hi:[0,1]
  v_pk_fma_f32 v[98:99], v[96:97], v[94:95], v[90:91] op_sel:[1,1,0] op_sel_hi:[1,0,1] neg_lo:[1,0,0]
  v_cvt_pk_bf16_f32 v115, v98, v99
  v_cvt_pk_bf16_f32 v154, v84, v85
  v_pk_mul_f32 v[92:93], v[84:85], v[80:81] op_sel:[0,0] op_sel_hi:[0,1]
  v_pk_fma_f32 v[84:85], v[84:85], v[80:81], v[92:93] op_sel:[1,1,0] op_sel_hi:[1,0,1] neg_lo:[1,0,0]
  v_pk_mul_f32 v[90:91], v[98:99], v[94:95] op_sel:[0,0] op_sel_hi:[0,1]
  v_pk_fma_f32 v[100:101], v[98:99], v[94:95], v[90:91] op_sel:[1,1,0] op_sel_hi:[1,0,1] neg_lo:[1,0,0]
  v_cvt_pk_bf16_f32 v116, v100, v101
  v_cvt_pk_bf16_f32 v155, v84, v85
  v_pk_mul_f32 v[92:93], v[84:85], v[80:81] op_sel:[0,0] op_sel_hi:[0,1]
  v_pk_fma_f32 v[84:85], v[84:85], v[80:81], v[92:93] op_sel:[1,1,0] op_sel_hi:[1,0,1] neg_lo:[1,0,0]
  v_pk_mul_f32 v[90:91], v[100:101], v[94:95] op_sel:[0,0] op_sel_hi:[0,1]
  v_pk_fma_f32 v[102:103], v[100:101], v[94:95], v[90:91] op_sel:[1,1,0] op_sel_hi:[1,0,1] neg_lo:[1,0,0]
  v_cvt_pk_bf16_f32 v117, v102, v103
  v_cvt_pk_bf16_f32 v156, v84, v85
  v_pk_mul_f32 v[92:93], v[84:85], v[80:81] op_sel:[0,0] op_sel_hi:[0,1]
  v_pk_fma_f32 v[84:85], v[84:85], v[80:81], v[92:93] op_sel:[1,1,0] op_sel_hi:[1,0,1] neg_lo:[1,0,0]
  v_pk_mul_f32 v[90:91], v[102:103], v[94:95] op_sel:[0,0] op_sel_hi:[0,1]
  v_pk_fma_f32 v[104:105], v[102:103], v[94:95], v[90:91] op_sel:[1,1,0] op_sel_hi:[1,0,1] neg_lo:[1,0,0]
  v_cvt_pk_bf16_f32 v118, v104, v105
  v_cvt_pk_bf16_f32 v157, v84, v85
  v_pk_mul_f32 v[92:93], v[84:85], v[80:81] op_sel:[0,0] op_sel_hi:[0,1]
  v_pk_fma_f32 v[84:85], v[84:85], v[80:81], v[92:93] op_sel:[1,1,0] op_sel_hi:[1,0,1] neg_lo:[1,0,0]
  v_pk_mul_f32 v[90:91], v[104:105], v[94:95] op_sel:[0,0] op_sel_hi:[0,1]
  v_pk_fma_f32 v[106:107], v[104:105], v[94:95], v[90:91] op_sel:[1,1,0] op_sel_hi:[1,0,1] neg_lo:[1,0,0]
  v_cvt_pk_bf16_f32 v119, v106, v107
  v_cvt_pk_bf16_f32 v158, v84, v85
  v_pk_mul_f32 v[92:93], v[84:85], v[80:81] op_sel:[0,0] op_sel_hi:[0,1]
  v_pk_fma_f32 v[84:85], v[84:85], v[80:81], v[92:93] op_sel:[1,1,0] op_sel_hi:[1,0,1] neg_lo:[1,0,0]
  v_cvt_pk_bf16_f32 v120, v82, v83
  v_pk_mul_f32 v[90:91], v[82:83], v[94:95] op_sel:[0,0] op_sel_hi:[0,1]
  v_pk_fma_f32 v[88:89], v[82:83], v[94:95], v[90:91] op_sel:[1,1,0] op_sel_hi:[1,0,1] neg_lo:[1,0,0]
  v_cvt_pk_bf16_f32 v121, v88, v89
  v_pk_mul_f32 v[90:91], v[82:83], v[96:97] op_sel:[0,0] op_sel_hi:[0,1]
  v_pk_fma_f32 v[88:89], v[82:83], v[96:97], v[90:91] op_sel:[1,1,0] op_sel_hi:[1,0,1] neg_lo:[1,0,0]
  v_cvt_pk_bf16_f32 v122, v88, v89
  v_pk_mul_f32 v[90:91], v[82:83], v[98:99] op_sel:[0,0] op_sel_hi:[0,1]
  v_pk_fma_f32 v[88:89], v[82:83], v[98:99], v[90:91] op_sel:[1,1,0] op_sel_hi:[1,0,1] neg_lo:[1,0,0]
  v_cvt_pk_bf16_f32 v123, v88, v89
  v_pk_mul_f32 v[90:91], v[82:83], v[100:101] op_sel:[0,0] op_sel_hi:[0,1]
  v_pk_fma_f32 v[88:89], v[82:83], v[100:101], v[90:91] op_sel:[1,1,0] op_sel_hi:[1,0,1] neg_lo:[1,0,0]
  v_cvt_pk_bf16_f32 v124, v88, v89
  v_pk_mul_f32 v[90:91], v[82:83], v[102:103] op_sel:[0,0] op_sel_hi:[0,1]
  v_pk_fma_f32 v[88:89], v[82:83], v[102:103], v[90:91] op_sel:[1,1,0] op_sel_hi:[1,0,1] neg_lo:[1,0,0]
  v_cvt_pk_bf16_f32 v125, v88, v89
  v_pk_mul_f32 v[90:91], v[82:83], v[104:105] op_sel:[0,0] op_sel_hi:[0,1]
  v_pk_fma_f32 v[88:89], v[82:83], v[104:105], v[90:91] op_sel:[1,1,0] op_sel_hi:[1,0,1] neg_lo:[1,0,0]
  v_cvt_pk_bf16_f32 v126, v88, v89
  v_pk_mul_f32 v[90:91], v[82:83], v[106:107] op_sel:[0,0] op_sel_hi:[0,1]
  v_pk_fma_f32 v[88:89], v[82:83], v[106:107], v[90:91] op_sel:[1,1,0] op_sel_hi:[1,0,1] neg_lo:[1,0,0]
  v_cvt_pk_bf16_f32 v127, v88, v89
  v_cvt_pk_bf16_f32 v159, v84, v85
  v_pk_mul_f32 v[92:93], v[84:85], v[80:81] op_sel:[0,0] op_sel_hi:[0,1]
  v_pk_fma_f32 v[84:85], v[84:85], v[80:81], v[92:93] op_sel:[1,1,0] op_sel_hi:[1,0,1] neg_lo:[1,0,0]
  v_pk_mul_f32 v[90:91], v[82:83], v[82:83] op_sel:[0,0] op_sel_hi:[0,1]
  v_pk_fma_f32 v[86:87], v[82:83], v[82:83], v[90:91] op_sel:[1,1,0] op_sel_hi:[1,0,1] neg_lo:[1,0,0]
  v_cvt_pk_bf16_f32 v128, v86, v87
  v_pk_mul_f32 v[90:91], v[86:87], v[96:97] op_sel:[0,0] op_sel_hi:[0,1]
  v_pk_fma_f32 v[88:89], v[86:87], v[96:97], v[90:91] op_sel:[1,1,0] op_sel_hi:[1,0,1] neg_lo:[1,0,0]
  v_cvt_pk_bf16_f32 v129, v88, v89
  v_pk_mul_f32 v[90:91], v[86:87], v[100:101] op_sel:[0,0] op_sel_hi:[0,1]
  v_pk_fma_f32 v[88:89], v[86:87], v[100:101], v[90:91] op_sel:[1,1,0] op_sel_hi:[1,0,1] neg_lo:[1,0,0]
  v_cvt_pk_bf16_f32 v130, v88, v89
  v_pk_mul_f32 v[90:91], v[86:87], v[104:105] op_sel:[0,0] op_sel_hi:[0,1]
  v_pk_fma_f32 v[88:89], v[86:87], v[104:105], v[90:91] op_sel:[1,1,0] op_sel_hi:[1,0,1] neg_lo:[1,0,0]
  v_cvt_pk_bf16_f32 v131, v88, v89
  v_cvt_pk_bf16_f32 v160, v84, v85
  v_pk_mul_f32 v[92:93], v[84:85], v[80:81] op_sel:[0,0] op_sel_hi:[0,1]
  v_pk_fma_f32 v[84:85], v[84:85], v[80:81], v[92:93] op_sel:[1,1,0] op_sel_hi:[1,0,1] neg_lo:[1,0,0]
  v_pk_mul_f32 v[90:91], v[86:87], v[82:83] op_sel:[0,0] op_sel_hi:[0,1]
  v_pk_fma_f32 v[86:87], v[86:87], v[82:83], v[90:91] op_sel:[1,1,0] op_sel_hi:[1,0,1] neg_lo:[1,0,0]
  v_cvt_pk_bf16_f32 v132, v86, v87
  v_pk_mul_f32 v[90:91], v[86:87], v[96:97] op_sel:[0,0] op_sel_hi:[0,1]
  v_pk_fma_f32 v[88:89], v[86:87], v[96:97], v[90:91] op_sel:[1,1,0] op_sel_hi:[1,0,1] neg_lo:[1,0,0]
  v_cvt_pk_bf16_f32 v133, v88, v89
  v_pk_mul_f32 v[90:91], v[86:87], v[100:101] op_sel:[0,0] op_sel_hi:[0,1]
  v_pk_fma_f32 v[88:89], v[86:87], v[100:101], v[90:91] op_sel:[1,1,0] op_sel_hi:[1,0,1] neg_lo:[1,0,0]
  v_cvt_pk_bf16_f32 v134, v88, v89
  v_pk_mul_f32 v[90:91], v[86:87], v[104:105] op_sel:[0,0] op_sel_hi:[0,1]
  v_pk_fma_f32 v[88:89], v[86:87], v[104:105], v[90:91] op_sel:[1,1,0] op_sel_hi:[1,0,1] neg_lo:[1,0,0]
  v_cvt_pk_bf16_f32 v135, v88, v89
  v_cvt_pk_bf16_f32 v161, v84, v85
  v_pk_mul_f32 v[92:93], v[84:85], v[80:81] op_sel:[0,0] op_sel_hi:[0,1]
  v_pk_fma_f32 v[84:85], v[84:85], v[80:81], v[92:93] op_sel:[1,1,0] op_sel_hi:[1,0,1] neg_lo:[1,0,0]
  v_pk_mul_f32 v[90:91], v[86:87], v[82:83] op_sel:[0,0] op_sel_hi:[0,1]
  v_pk_fma_f32 v[86:87], v[86:87], v[82:83], v[90:91] op_sel:[1,1,0] op_sel_hi:[1,0,1] neg_lo:[1,0,0]
  v_cvt_pk_bf16_f32 v136, v86, v87
  v_pk_mul_f32 v[90:91], v[86:87], v[100:101] op_sel:[0,0] op_sel_hi:[0,1]
  v_pk_fma_f32 v[88:89], v[86:87], v[100:101], v[90:91] op_sel:[1,1,0] op_sel_hi:[1,0,1] neg_lo:[1,0,0]
  v_cvt_pk_bf16_f32 v137, v88, v89
  v_cvt_pk_bf16_f32 v162, v84, v85
  v_pk_mul_f32 v[92:93], v[84:85], v[80:81] op_sel:[0,0] op_sel_hi:[0,1]
  v_pk_fma_f32 v[84:85], v[84:85], v[80:81], v[92:93] op_sel:[1,1,0] op_sel_hi:[1,0,1] neg_lo:[1,0,0]
  v_pk_mul_f32 v[90:91], v[86:87], v[82:83] op_sel:[0,0] op_sel_hi:[0,1]
  v_pk_fma_f32 v[86:87], v[86:87], v[82:83], v[90:91] op_sel:[1,1,0] op_sel_hi:[1,0,1] neg_lo:[1,0,0]
  v_cvt_pk_bf16_f32 v138, v86, v87
  v_pk_mul_f32 v[90:91], v[86:87], v[100:101] op_sel:[0,0] op_sel_hi:[0,1]
  v_pk_fma_f32 v[88:89], v[86:87], v[100:101], v[90:91] op_sel:[1,1,0] op_sel_hi:[1,0,1] neg_lo:[1,0,0]
  v_cvt_pk_bf16_f32 v139, v88, v89
  v_cvt_pk_bf16_f32 v163, v84, v85
  v_pk_mul_f32 v[92:93], v[84:85], v[80:81] op_sel:[0,0] op_sel_hi:[0,1]
  v_pk_fma_f32 v[84:85], v[84:85], v[80:81], v[92:93] op_sel:[1,1,0] op_sel_hi:[1,0,1] neg_lo:[1,0,0]
  v_pk_mul_f32 v[90:91], v[86:87], v[82:83] op_sel:[0,0] op_sel_hi:[0,1]
  v_pk_fma_f32 v[86:87], v[86:87], v[82:83], v[90:91] op_sel:[1,1,0] op_sel_hi:[1,0,1] neg_lo:[1,0,0]
  v_cvt_pk_bf16_f32 v140, v86, v87
  v_pk_mul_f32 v[90:91], v[86:87], v[100:101] op_sel:[0,0] op_sel_hi:[0,1]
  v_pk_fma_f32 v[88:89], v[86:87], v[100:101], v[90:91] op_sel:[1,1,0] op_sel_hi:[1,0,1] neg_lo:[1,0,0]
  v_cvt_pk_bf16_f32 v141, v88, v89
  v_cvt_pk_bf16_f32 v164, v84, v85
  v_pk_mul_f32 v[92:93], v[84:85], v[80:81] op_sel:[0,0] op_sel_hi:[0,1]
  v_pk_fma_f32 v[84:85], v[84:85], v[80:81], v[92:93] op_sel:[1,1,0] op_sel_hi:[1,0,1] neg_lo:[1,0,0]
  v_pk_mul_f32 v[90:91], v[86:87], v[82:83] op_sel:[0,0] op_sel_hi:[0,1]
  v_pk_fma_f32 v[86:87], v[86:87], v[82:83], v[90:91] op_sel:[1,1,0] op_sel_hi:[1,0,1] neg_lo:[1,0,0]
  v_cvt_pk_bf16_f32 v142, v86, v87
  v_pk_mul_f32 v[90:91], v[86:87], v[100:101] op_sel:[0,0] op_sel_hi:[0,1]
  v_pk_fma_f32 v[88:89], v[86:87], v[100:101], v[90:91] op_sel:[1,1,0] op_sel_hi:[1,0,1] neg_lo:[1,0,0]
  v_cvt_pk_bf16_f32 v143, v88, v89
  v_cvt_pk_bf16_f32 v165, v84, v85
  v_pk_mul_f32 v[92:93], v[84:85], v[80:81] op_sel:[0,0] op_sel_hi:[0,1]
  v_pk_fma_f32 v[84:85], v[84:85], v[80:81], v[92:93] op_sel:[1,1,0] op_sel_hi:[1,0,1] neg_lo:[1,0,0]
  v_pk_mul_f32 v[90:91], v[86:87], v[82:83] op_sel:[0,0] op_sel_hi:[0,1]
  v_pk_fma_f32 v[86:87], v[86:87], v[82:83], v[90:91] op_sel:[1,1,0] op_sel_hi:[1,0,1] neg_lo:[1,0,0]
  v_cvt_pk_bf16_f32 v144, v86, v87
  v_cvt_pk_bf16_f32 v166, v84, v85
  v_pk_mul_f32 v[92:93], v[84:85], v[80:81] op_sel:[0,0] op_sel_hi:[0,1]
  v_pk_fma_f32 v[84:85], v[84:85], v[80:81], v[92:93] op_sel:[1,1,0] op_sel_hi:[1,0,1] neg_lo:[1,0,0]
  v_pk_mul_f32 v[90:91], v[86:87], v[82:83] op_sel:[0,0] op_sel_hi:[0,1]
  v_pk_fma_f32 v[86:87], v[86:87], v[82:83], v[90:91] op_sel:[1,1,0] op_sel_hi:[1,0,1] neg_lo:[1,0,0]
  v_cvt_pk_bf16_f32 v145, v86, v87
  v_cvt_pk_bf16_f32 v167, v84, v85
  v_pk_mul_f32 v[92:93], v[84:85], v[80:81] op_sel:[0,0] op_sel_hi:[0,1]
  v_pk_fma_f32 v[84:85], v[84:85], v[80:81], v[92:93] op_sel:[1,1,0] op_sel_hi:[1,0,1] neg_lo:[1,0,0]
  v_pk_mul_f32 v[90:91], v[86:87], v[82:83] op_sel:[0,0] op_sel_hi:[0,1]
  v_pk_fma_f32 v[86:87], v[86:87], v[82:83], v[90:91] op_sel:[1,1,0] op_sel_hi:[1,0,1] neg_lo:[1,0,0]
  v_cvt_pk_bf16_f32 v146, v86, v87
  v_cvt_pk_bf16_f32 v168, v84, v85
  v_pk_mul_f32 v[90:91], v[86:87], v[82:83] op_sel:[0,0] op_sel_hi:[0,1]
  v_pk_fma_f32 v[86:87], v[86:87], v[82:83], v[90:91] op_sel:[1,1,0] op_sel_hi:[1,0,1] neg_lo:[1,0,0]
  v_cvt_pk_bf16_f32 v147, v86, v87
  v_pk_mul_f32 v[90:91], v[86:87], v[82:83] op_sel:[0,0] op_sel_hi:[0,1]
  v_pk_fma_f32 v[86:87], v[86:87], v[82:83], v[90:91] op_sel:[1,1,0] op_sel_hi:[1,0,1] neg_lo:[1,0,0]
  v_cvt_pk_bf16_f32 v148, v86, v87
  v_pk_mul_f32 v[90:91], v[86:87], v[82:83] op_sel:[0,0] op_sel_hi:[0,1]
  v_pk_fma_f32 v[86:87], v[86:87], v[82:83], v[90:91] op_sel:[1,1,0] op_sel_hi:[1,0,1] neg_lo:[1,0,0]
  v_cvt_pk_bf16_f32 v149, v86, v87
  v_pk_mul_f32 v[90:91], v[86:87], v[82:83] op_sel:[0,0] op_sel_hi:[0,1]
  v_pk_fma_f32 v[86:87], v[86:87], v[82:83], v[90:91] op_sel:[1,1,0] op_sel_hi:[1,0,1] neg_lo:[1,0,0]
  v_cvt_pk_bf16_f32 v150, v86, v87
  v_pk_mul_f32 v[90:91], v[86:87], v[82:83] op_sel:[0,0] op_sel_hi:[0,1]
  v_pk_fma_f32 v[86:87], v[86:87], v[82:83], v[90:91] op_sel:[1,1,0] op_sel_hi:[1,0,1] neg_lo:[1,0,0]
  v_cvt_pk_bf16_f32 v151, v86, v87
  v_pk_mul_f32 v[90:91], v[86:87], v[82:83] op_sel:[0,0] op_sel_hi:[0,1]
  v_pk_fma_f32 v[86:87], v[86:87], v[82:83], v[90:91] op_sel:[1,1,0] op_sel_hi:[1,0,1] neg_lo:[1,0,0]
  v_cvt_pk_bf16_f32 v152, v86, v87
  s_waitcnt vmcnt(0)
  s_barrier
  s_cmp_lg_u32 s3, 0
  s_cbranch_scc1 Lgfskip
  s_mov_b64 exec, 1
  global_store_dwordx2 v245, v[196:197], s[66:67] sc1
  s_mov_b64 exec, -1
Lgfskip:
  ds_read_b64_tr_b16 v[176:177], v43
  ds_read_b64_tr_b16 v[178:179], v43 offset:8
  ds_read_b64_tr_b16 v[180:181], v43 offset:16
  ds_read_b64_tr_b16 v[182:183], v43 offset:24
  v_mov_b32 v5, s76
  v_mov_b32 v7, s74
  v_mov_b32 v9, s76
  v_mov_b32 v11, s74
  v_mov_b32 v13, s76
  v_mov_b32 v15, s74
  v_mov_b32 v17, s76
  v_mov_b32 v19, s74
  s_waitcnt lgkmcnt(3)
  v_mov_b32 v4, v176
  v_mov_b32 v6, v177
  global_store_dwordx4 v44, v[4:7], s[44:45] sc1
  s_waitcnt lgkmcnt(2)
  v_mov_b32 v8, v178
  v_mov_b32 v10, v179
  global_store_dwordx4 v44, v[8:11], s[46:47] sc1
  s_waitcnt lgkmcnt(1)
  v_mov_b32 v12, v180
  v_mov_b32 v14, v181
  global_store_dwordx4 v44, v[12:15], s[48:49] sc1
  s_waitcnt lgkmcnt(0)
  v_mov_b32 v16, v182
  v_mov_b32 v18, v183
  global_store_dwordx4 v44, v[16:19], s[50:51] sc1
  ds_read_u16 v60, v248 offset:0
  ds_read_u16 v61, v248 offset:128
  ds_read_u16 v62, v248 offset:256
  ds_read_u16 v63, v248 offset:384
  ds_read_u16 v64, v248 offset:512
  ds_read_u16 v65, v248 offset:640
  ds_read_u16 v66, v248 offset:768
  ds_read_u16 v67, v248 offset:896
  s_waitcnt lgkmcnt(0)
  ds_read_u16 v68, v248 offset:1024
  ds_read_u16 v69, v248 offset:1152
  ds_read_u16 v70, v248 offset:1280
  ds_read_u16 v71, v248 offset:1408
  ds_read_u16 v72, v248 offset:1536
  ds_read_u16 v73, v248 offset:1664
  ds_read_u16 v74, v248 offset:1792
  ds_read_u16 v75, v248 offset:1920
  ds_write_b32 v45, v112 offset:0
  ds_write_b32 v45, v113 offset:544
  ds_write_b32 v45, v114 offset:1088
  ds_write_b32 v45, v115 offset:1632
  ds_write_b32 v45, v116 offset:2176
  ds_write_b32 v45, v117 offset:2720
  ds_write_b32 v45, v118 offset:3264
  ds_write_b32 v45, v119 offset:3808
  ds_write_b32 v45, v120 offset:4352
  ds_write_b32 v45, v121 offset:4896
  ds_write_b32 v45, v122 offset:5440
  ds_write_b32 v45, v123 offset:5984
  ds_write_b32 v45, v124 offset:6528
  ds_write_b32 v45, v125 offset:7072
  ds_write_b32 v45, v126 offset:7616
  ds_write_b32 v45, v127 offset:8160
  ds_write_b32 v45, v128 offset:8704
  ds_write_b32 v45, v129 offset:9248
  ds_write_b32 v45, v130 offset:9792
  ds_write_b32 v45, v131 offset:10336
  ds_write_b32 v45, v132 offset:10880
  ds_write_b32 v45, v133 offset:11424
  ds_write_b32 v45, v134 offset:11968
  ds_write_b32 v45, v135 offset:12512
  ds_write_b32 v45, v136 offset:13056
  ds_write_b32 v45, v137 offset:13600
  ds_write_b32 v45, v138 offset:14144
  ds_write_b32 v45, v139 offset:14688
  ds_write_b32 v45, v140 offset:15232
  ds_write_b32 v45, v141 offset:15776
  ds_write_b32 v45, v142 offset:16320
  ds_write_b32 v45, v143 offset:16864
  ds_write_b32 v45, v144 offset:17408
  ds_write_b32 v45, v145 offset:17952
  ds_write_b32 v45, v146 offset:18496
  ds_write_b32 v45, v147 offset:19040
  ds_write_b32 v45, v148 offset:19584
  ds_write_b32 v45, v149 offset:20128
  ds_write_b32 v45, v150 offset:20672
  ds_write_b32 v45, v151 offset:21216
  ds_write_b32 v45, v152 offset:21760
  ds_write_b32 v45, v153 offset:22304
  ds_write_b32 v45, v154 offset:22848
  ds_write_b32 v45, v155 offset:23392
  ds_write_b32 v45, v156 offset:23936
  ds_write_b32 v45, v157 offset:24480
  ds_write_b32 v45, v158 offset:25024
  ds_write_b32 v45, v159 offset:25568
  ds_write_b32 v45, v160 offset:26112
  ds_write_b32 v45, v161 offset:26656
  ds_write_b32 v45, v162 offset:27200
  ds_write_b32 v45, v163 offset:27744
  ds_write_b32 v45, v164 offset:28288
  ds_write_b32 v45, v165 offset:28832
  ds_write_b32 v45, v166 offset:29376
  ds_write_b32 v45, v167 offset:29920
  ds_write_b32 v45, v168 offset:30464
  s_mov_b32 s73, 1
  s_waitcnt lgkmcnt(0)
  s_barrier
  ds_read_b128 v[76:79], v48 offset:22304
  ds_read_b128 v[108:111], v49 offset:0
  ds_read_b128 v[140:143], v48 offset:17408
  ds_read_b128 v[80:83], v48 offset:22368
  ds_read_b128 v[112:115], v49 offset:64
  ds_read_b128 v[144:147], v48 offset:17472
  ds_read_b128 v[84:87], v48 offset:22432
  ds_read_b128 v[116:119], v49 offset:128
  ds_read_b128 v[148:151], v48 offset:17536
  ds_read_b128 v[88:91], v48 offset:22496
  ds_read_b128 v[120:123], v49 offset:192
  ds_read_b128 v[152:155], v48 offset:17600
  s_waitcnt lgkmcnt(9)
  v_mfma_f32_16x16x32_bf16 v[200:203], v[108:111], v[76:79], 0
  v_mfma_f32_16x16x32_bf16 v[204:207], v[140:143], v[76:79], 0
  ds_read_b128 v[92:95], v48 offset:22560
  ds_read_b128 v[124:127], v49 offset:256
  ds_read_b128 v[156:159], v48 offset:17664
  s_waitcnt lgkmcnt(9)
  v_mfma_f32_16x16x32_bf16 v[200:203], v[112:115], v[80:83], v[200:203]
  v_mfma_f32_16x16x32_bf16 v[204:207], v[144:147], v[80:83], v[204:207]
  ds_read_b128 v[96:99], v48 offset:22624
  ds_read_b128 v[128:131], v49 offset:320
  ds_read_b128 v[160:163], v48 offset:17728
  s_waitcnt lgkmcnt(9)
  v_mfma_f32_16x16x32_bf16 v[200:203], v[116:119], v[84:87], v[200:203]
  v_mfma_f32_16x16x32_bf16 v[204:207], v[148:151], v[84:87], v[204:207]
  ds_read_b128 v[100:103], v48 offset:22688
  ds_read_b128 v[132:135], v49 offset:384
  ds_read_b128 v[164:167], v48 offset:17792
  s_waitcnt lgkmcnt(9)
  v_mfma_f32_16x16x32_bf16 v[200:203], v[120:123], v[88:91], v[200:203]
  v_mfma_f32_16x16x32_bf16 v[204:207], v[152:155], v[88:91], v[204:207]
  ds_read_b128 v[104:107], v48 offset:22752
  ds_read_b128 v[136:139], v49 offset:448
  ds_read_b128 v[168:171], v48 offset:17856
  s_waitcnt lgkmcnt(9)
  v_mfma_f32_16x16x32_bf16 v[200:203], v[124:127], v[92:95], v[200:203]
  v_mfma_f32_16x16x32_bf16 v[204:207], v[156:159], v[92:95], v[204:207]
  s_waitcnt lgkmcnt(6)
  v_mfma_f32_16x16x32_bf16 v[200:203], v[128:131], v[96:99], v[200:203]
  v_mfma_f32_16x16x32_bf16 v[204:207], v[160:163], v[96:99], v[204:207]
  s_waitcnt lgkmcnt(3)
  v_mfma_f32_16x16x32_bf16 v[200:203], v[132:135], v[100:103], v[200:203]
  v_mfma_f32_16x16x32_bf16 v[204:207], v[164:167], v[100:103], v[204:207]
  s_waitcnt lgkmcnt(0)
  v_mfma_f32_16x16x32_bf16 v[200:203], v[136:139], v[104:107], v[200:203]
  v_mfma_f32_16x16x32_bf16 v[204:207], v[168:171], v[104:107], v[204:207]
  s_nop 6
  ds_write_b64 v51, v[200:201]
  ds_write_b64 v52, v[202:203]
  ds_write_b32 v50, v204
  ds_write_b32 v50, v205 offset:64
  ds_write_b32 v50, v206 offset:128
  ds_write_b32 v50, v207 offset:192
  s_waitcnt lgkmcnt(0)
  s_barrier
  ds_read_b32 v76, v20
  ds_read_b32 v77, v21
  ds_read_b32 v78, v22
  ds_read_b32 v79, v23
  ds_read_b32 v80, v24
  ds_read_b32 v81, v25
  ds_read_b32 v82, v26
  ds_read_b32 v83, v27
  ds_read_b32 v84, v28
  ds_read_b32 v85, v29
  ds_read_b32 v86, v30
  ds_read_b32 v87, v31
  ds_read_b32 v88, v32
  s_waitcnt lgkmcnt(2)
  ds_read_b32 v89, v33
  ds_read_b32 v90, v34
  ds_read_b32 v91, v35
  ds_read_b32 v92, v36
  ds_read_b32 v93, v37
  ds_read_b32 v94, v38
  ds_read_b32 v95, v39
  ds_read_b32 v96, v40
  ds_read_b32 v97, v41
  v_cvt_pk_bf16_f32 v100, v83, v82
  v_cvt_pk_bf16_f32 v101, v81, v80
  v_cvt_pk_bf16_f32 v102, v79, v78
  v_cvt_pk_bf16_f32 v103, v77, v76
  ds_write_b128 v53, v[100:103] offset:0
  v_cvt_pk_bf16_f32 v104, v84, v83
  v_cvt_pk_bf16_f32 v105, v82, v81
  v_cvt_pk_bf16_f32 v106, v80, v79
  v_cvt_pk_bf16_f32 v107, v78, v77
  ds_write_b128 v53, v[104:107] offset:4160
  v_cvt_pk_bf16_f32 v108, v85, v84
  v_cvt_pk_bf16_f32 v109, v83, v82
  v_cvt_pk_bf16_f32 v110, v81, v80
  v_cvt_pk_bf16_f32 v111, v79, v78
  ds_write_b128 v53, v[108:111] offset:8320
  v_cvt_pk_bf16_f32 v112, v86, v85
  v_cvt_pk_bf16_f32 v113, v84, v83
  v_cvt_pk_bf16_f32 v114, v82, v81
  v_cvt_pk_bf16_f32 v115, v80, v79
  ds_write_b128 v53, v[112:115] offset:12480
  s_waitcnt lgkmcnt(4)
  v_cvt_pk_bf16_f32 v116, v94, v93
  v_cvt_pk_bf16_f32 v117, v92, v91
  v_cvt_pk_bf16_f32 v118, v90, v89
  v_cvt_pk_bf16_f32 v119, v88, v87
  ds_write_b128 v53, v[116:119] offset:1024
  v_cvt_pk_bf16_f32 v120, v95, v94
  v_cvt_pk_bf16_f32 v121, v93, v92
  v_cvt_pk_bf16_f32 v122, v91, v90
  v_cvt_pk_bf16_f32 v123, v89, v88
  ds_write_b128 v53, v[120:123] offset:5184
  v_cvt_pk_bf16_f32 v124, v96, v95
  v_cvt_pk_bf16_f32 v125, v94, v93
  v_cvt_pk_bf16_f32 v126, v92, v91
  v_cvt_pk_bf16_f32 v127, v90, v89
  ds_write_b128 v53, v[124:127] offset:9344
  v_cvt_pk_bf16_f32 v128, v97, v96
  v_cvt_pk_bf16_f32 v129, v95, v94
  v_cvt_pk_bf16_f32 v130, v93, v92
  v_cvt_pk_bf16_f32 v131, v91, v90
  ds_write_b128 v53, v[128:131] offset:13504
  global_load_dwordx4 v[176:179], v57, s[16:17]
  global_load_dwordx4 v[180:183], v57, s[18:19]
  global_load_dwordx4 v[184:187], v57, s[20:21]
  global_load_dwordx4 v[188:191], v57, s[22:23]
  v_and_b32 v238, 31, v1
  s_lshl_b32 s8, s6, 8
  s_add_u32 s8, s8, 151552
  v_lshl_add_u32 v238, v238, 3, s8
  s_mov_b32 s79, 0
  v_mov_b32 v132, 0
  v_mov_b32 v133, 0
  v_mov_b32 v134, 0
  v_mov_b32 v135, 0
  s_cmp_eq_u32 s12, 0
  s_cbranch_scc0 Lh1_22
  v_lshl_add_u32 v136, v1, 3, s64
  ds_write_b64 v136, v[132:133]
  s_branch Lh2_23
Lh1_22:
  v_mov_b32 v138, 0
  v_mov_b32 v139, 0
  v_mov_b32 v142, 0
  v_mov_b32 v143, 0
  v_mov_b32 v146, 0
  v_mov_b32 v147, 0
  v_cvt_pk_bf16_f32 v136, v87, v132
  v_mov_b32 v137, 0
  v_cvt_pk_bf16_f32 v140, v88, v87
  v_mov_b32 v141, 0
  v_cvt_pk_bf16_f32 v144, v89, v88
  v_cvt_pk_bf16_f32 v145, v87, v132
  s_mov_b32 exec_lo, 0
  s_mov_b32 exec_hi, 0x80000000
  ds_write_b128 v53, v[132:135] offset:1040
  ds_write_b128 v53, v[132:135] offset:1056
  ds_write_b128 v53, v[136:139] offset:5200
  ds_write_b128 v53, v[132:135] offset:5216
  ds_write_b128 v53, v[140:143] offset:9360
  ds_write_b128 v53, v[132:135] offset:9376
  ds_write_b128 v53, v[144:147] offset:13520
  ds_write_b128 v53, v[132:135] offset:13536
  s_mov_b64 exec, -1
Lh2_23:
  s_mov_b32 s13, 0
  s_branch Luf_chk_26
Luf_24:
  s_sleep 6
  s_mov_b64 exec, s[36:37]
  s_cbranch_execz Luf_s_28
  global_load_dwordx4 v[176:179], v57, s[16:17] sc1
Luf_s_28:
  s_mov_b64 exec, s[38:39]
  s_cbranch_execz Luf_s_29
  global_load_dwordx4 v[180:183], v57, s[18:19] sc1
Luf_s_29:
  s_mov_b64 exec, s[40:41]
  s_cbranch_execz Luf_s_30
  global_load_dwordx4 v[184:187], v57, s[20:21] sc1
Luf_s_30:
  s_mov_b64 exec, s[42:43]
  s_cbranch_execz Luf_s_31
  global_load_dwordx4 v[188:191], v57, s[22:23] sc1
Luf_s_31:
  s_mov_b64 exec, -1
  s_add_u32 s13, s13, 1
Luf_chk_26:
  s_waitcnt vmcnt(0)
Luf_chk2_27:
  v_mov_b32 v251, 0
  v_xor_b32 v253, s75, v177
  v_xor_b32 v254, s74, v179
  v_or_b32 v251, v251, v254
  v_and_or_b32 v253, v254, -8, v253
  v_cmp_ne_u32 s[36:37], 0, v253
  v_xor_b32 v253, s75, v181
  v_xor_b32 v254, s74, v183
  v_or_b32 v251, v251, v254
  v_and_or_b32 v253, v254, -8, v253
  v_cmp_ne_u32 s[38:39], 0, v253
  v_xor_b32 v253, s75, v185
  v_xor_b32 v254, s74, v187
  v_or_b32 v251, v251, v254
  v_and_or_b32 v253, v254, -8, v253
  v_cmp_ne_u32 s[40:41], 0, v253
  v_xor_b32 v253, s75, v189
  v_xor_b32 v254, s74, v191
  v_or_b32 v251, v251, v254
  v_and_or_b32 v253, v254, -8, v253
  v_cmp_ne_u32 s[42:43], 0, v253
  s_or_b64 s[8:9], s[36:37], s[38:39]
  s_or_b64 s[10:11], s[40:41], s[42:43]
  s_or_b64 s[8:9], s[8:9], s[10:11]
  s_cbranch_scc0 Luf_done_25
  s_cmp_lt_u32 s13, 131072
  s_cbranch_scc1 Luf_24
Luf_done_25:
  ds_write2_b32 v58, v176, v178 offset0:0 offset1:1
  v_add_u32 v58, 1024, v58
  ds_write2_b32 v58, v180, v182 offset0:0 offset1:1
  v_add_u32 v58, 1024, v58
  ds_write2_b32 v58, v184, v186 offset0:0 offset1:1
  v_add_u32 v58, 1024, v58
  ds_write2_b32 v58, v188, v190 offset0:0 offset1:1
  s_waitcnt lgkmcnt(0)
  s_barrier
  global_load_dwordx2 v[236:237], v238, s[66:67] sc1
  ds_read_b128 v[140:143], v55 offset:192
  ds_read_b64 v[108:109], v54 offset:3776
  ds_read_b64 v[110:111], v54 offset:3784
  ds_read_b128 v[144:147], v55 offset:704
  ds_read_b64 v[112:113], v54 offset:3264
  ds_read_b64 v[114:115], v54 offset:3272
  ds_read_b128 v[148:151], v55 offset:1216
  ds_read_b64 v[116:117], v54 offset:2752
  ds_read_b64 v[118:119], v54 offset:2760
  ds_read_b128 v[152:155], v55 offset:1728
  ds_read_b64 v[120:121], v54 offset:2240
  ds_read_b64 v[122:123], v54 offset:2248
  s_waitcnt lgkmcnt(6)
  ds_read_b128 v[156:159], v55 offset:2240
  ds_read_b64 v[124:125], v54 offset:1728
  ds_read_b64 v[126:127], v54 offset:1736
  ds_read_b128 v[160:163], v55 offset:2752
  ds_read_b64 v[128:129], v54 offset:1216
  ds_read_b64 v[130:131], v54 offset:1224
  ds_read_b128 v[164:167], v55 offset:3264
  ds_read_b64 v[132:133], v54 offset:704
  ds_read_b64 v[134:135], v54 offset:712
  ds_read_b128 v[168:171], v55 offset:3776
  ds_read_b64 v[136:137], v54 offset:192
  ds_read_b64 v[138:139], v54 offset:200
  s_waitcnt lgkmcnt(0)
  v_mfma_f32_16x16x32_bf16 v[76:79], v[108:111], v[140:143], 0
  ds_read_b128 v[204:207], v55 offset:128
  v_mfma_f32_16x16x32_bf16 v[80:83], v[108:111], v[144:147], 0
  ds_read_b64 v[172:173], v54 offset:3712
  v_mfma_f32_16x16x32_bf16 v[84:87], v[108:111], v[148:151], 0
  ds_read_b64 v[174:175], v54 offset:3720
  v_mfma_f32_16x16x32_bf16 v[88:91], v[108:111], v[152:155], 0
  ds_read_b128 v[208:211], v55 offset:640
  v_mfma_f32_16x16x32_bf16 v[92:95], v[108:111], v[156:159], 0
  ds_read_b64 v[176:177], v54 offset:3200
  v_mfma_f32_16x16x32_bf16 v[96:99], v[108:111], v[160:163], 0
  ds_read_b64 v[178:179], v54 offset:3208
  v_mfma_f32_16x16x32_bf16 v[100:103], v[108:111], v[164:167], 0
  ds_read_b128 v[212:215], v55 offset:1152
  v_mfma_f32_16x16x32_bf16 v[104:107], v[108:111], v[168:171], 0
  ds_read_b64 v[180:181], v54 offset:2688
  v_mfma_f32_16x16x32_bf16 v[80:83], v[112:115], v[140:143], v[80:83]
  ds_read_b64 v[182:183], v54 offset:2696
  v_mfma_f32_16x16x32_bf16 v[84:87], v[112:115], v[144:147], v[84:87]
  ds_read_b128 v[216:219], v55 offset:1664
  v_mfma_f32_16x16x32_bf16 v[88:91], v[112:115], v[148:151], v[88:91]
  ds_read_b64 v[184:185], v54 offset:2176
  v_mfma_f32_16x16x32_bf16 v[92:95], v[112:115], v[152:155], v[92:95]
  ds_read_b64 v[186:187], v54 offset:2184
  s_waitcnt lgkmcnt(6)
  v_mfma_f32_16x16x32_bf16 v[96:99], v[112:115], v[156:159], v[96:99]
  ds_read_b128 v[220:223], v55 offset:2176
  v_mfma_f32_16x16x32_bf16 v[100:103], v[112:115], v[160:163], v[100:103]
  ds_read_b64 v[188:189], v54 offset:1664
  v_mfma_f32_16x16x32_bf16 v[104:107], v[112:115], v[164:167], v[104:107]
  ds_read_b64 v[190:191], v54 offset:1672
  v_mfma_f32_16x16x32_bf16 v[84:87], v[116:119], v[140:143], v[84:87]
  ds_read_b128 v[224:227], v55 offset:2688
  v_mfma_f32_16x16x32_bf16 v[88:91], v[116:119], v[144:147], v[88:91]
  ds_read_b64 v[192:193], v54 offset:1152
  v_mfma_f32_16x16x32_bf16 v[92:95], v[116:119], v[148:151], v[92:95]
  ds_read_b64 v[194:195], v54 offset:1160
  v_mfma_f32_16x16x32_bf16 v[96:99], v[116:119], v[152:155], v[96:99]
  ds_read_b128 v[228:231], v55 offset:3200
  v_mfma_f32_16x16x32_bf16 v[100:103], v[116:119], v[156:159], v[100:103]
  ds_read_b64 v[196:197], v54 offset:640
  v_mfma_f32_16x16x32_bf16 v[104:107], v[116:119], v[160:163], v[104:107]
  ds_read_b64 v[198:199], v54 offset:648
  v_mfma_f32_16x16x32_bf16 v[88:91], v[120:123], v[140:143], v[88:91]
  ds_read_b128 v[232:235], v55 offset:3712
  v_mfma_f32_16x16x32_bf16 v[92:95], v[120:123], v[144:147], v[92:95]
  ds_read_b64 v[200:201], v54 offset:128
  v_mfma_f32_16x16x32_bf16 v[96:99], v[120:123], v[148:151], v[96:99]
  ds_read_b64 v[202:203], v54 offset:136
  v_mfma_f32_16x16x32_bf16 v[100:103], v[120:123], v[152:155], v[100:103]
  v_mfma_f32_16x16x32_bf16 v[104:107], v[120:123], v[156:159], v[104:107]
  v_mfma_f32_16x16x32_bf16 v[92:95], v[124:127], v[140:143], v[92:95]
  v_mfma_f32_16x16x32_bf16 v[96:99], v[124:127], v[144:147], v[96:99]
  v_mfma_f32_16x16x32_bf16 v[100:103], v[124:127], v[148:151], v[100:103]
  v_mfma_f32_16x16x32_bf16 v[104:107], v[124:127], v[152:155], v[104:107]
  v_mfma_f32_16x16x32_bf16 v[96:99], v[128:131], v[140:143], v[96:99]
  v_mfma_f32_16x16x32_bf16 v[100:103], v[128:131], v[144:147], v[100:103]
  v_mfma_f32_16x16x32_bf16 v[104:107], v[128:131], v[148:151], v[104:107]
  v_mfma_f32_16x16x32_bf16 v[100:103], v[132:135], v[140:143], v[100:103]
  v_mfma_f32_16x16x32_bf16 v[104:107], v[132:135], v[144:147], v[104:107]
  v_mfma_f32_16x16x32_bf16 v[104:107], v[136:139], v[140:143], v[104:107]
  s_waitcnt lgkmcnt(0)
  v_mfma_f32_16x16x32_bf16 v[76:79], v[172:175], v[204:207], v[76:79]
  ds_read_b128 v[140:143], v55 offset:64
  v_mfma_f32_16x16x32_bf16 v[80:83], v[172:175], v[208:211], v[80:83]
  ds_read_b64 v[108:109], v54 offset:3648
  v_mfma_f32_16x16x32_bf16 v[84:87], v[172:175], v[212:215], v[84:87]
  ds_read_b64 v[110:111], v54 offset:3656
  v_mfma_f32_16x16x32_bf16 v[88:91], v[172:175], v[216:219], v[88:91]
  ds_read_b128 v[144:147], v55 offset:576
  v_mfma_f32_16x16x32_bf16 v[92:95], v[172:175], v[220:223], v[92:95]
  ds_read_b64 v[112:113], v54 offset:3136
  v_mfma_f32_16x16x32_bf16 v[96:99], v[172:175], v[224:227], v[96:99]
  ds_read_b64 v[114:115], v54 offset:3144
  v_mfma_f32_16x16x32_bf16 v[100:103], v[172:175], v[228:231], v[100:103]
  ds_read_b128 v[148:151], v55 offset:1088
  v_mfma_f32_16x16x32_bf16 v[104:107], v[172:175], v[232:235], v[104:107]
  ds_read_b64 v[116:117], v54 offset:2624
  v_mfma_f32_16x16x32_bf16 v[80:83], v[176:179], v[204:207], v[80:83]
  ds_read_b64 v[118:119], v54 offset:2632
  v_mfma_f32_16x16x32_bf16 v[84:87], v[176:179], v[208:211], v[84:87]
  ds_read_b128 v[152:155], v55 offset:1600
  v_mfma_f32_16x16x32_bf16 v[88:91], v[176:179], v[212:215], v[88:91]
  ds_read_b64 v[120:121], v54 offset:2112
  v_mfma_f32_16x16x32_bf16 v[92:95], v[176:179], v[216:219], v[92:95]
  ds_read_b64 v[122:123], v54 offset:2120
  s_waitcnt lgkmcnt(6)
  v_mfma_f32_16x16x32_bf16 v[96:99], v[176:179], v[220:223], v[96:99]
  ds_read_b128 v[156:159], v55 offset:2112
  v_mfma_f32_16x16x32_bf16 v[100:103], v[176:179], v[224:227], v[100:103]
  ds_read_b64 v[124:125], v54 offset:1600
  v_mfma_f32_16x16x32_bf16 v[104:107], v[176:179], v[228:231], v[104:107]
  ds_read_b64 v[126:127], v54 offset:1608
  v_mfma_f32_16x16x32_bf16 v[84:87], v[180:183], v[204:207], v[84:87]
  ds_read_b128 v[160:163], v55 offset:2624
  v_mfma_f32_16x16x32_bf16 v[88:91], v[180:183], v[208:211], v[88:91]
  ds_read_b64 v[128:129], v54 offset:1088
  v_mfma_f32_16x16x32_bf16 v[92:95], v[180:183], v[212:215], v[92:95]
  ds_read_b64 v[130:131], v54 offset:1096
  v_mfma_f32_16x16x32_bf16 v[96:99], v[180:183], v[216:219], v[96:99]
  ds_read_b128 v[164:167], v55 offset:3136
  v_mfma_f32_16x16x32_bf16 v[100:103], v[180:183], v[220:223], v[100:103]
  ds_read_b64 v[132:133], v54 offset:576
  v_mfma_f32_16x16x32_bf16 v[104:107], v[180:183], v[224:227], v[104:107]
  ds_read_b64 v[134:135], v54 offset:584
  v_mfma_f32_16x16x32_bf16 v[88:91], v[184:187], v[204:207], v[88:91]
  ds_read_b128 v[168:171], v55 offset:3648
  v_mfma_f32_16x16x32_bf16 v[92:95], v[184:187], v[208:211], v[92:95]
  ds_read_b64 v[136:137], v54 offset:64
  v_mfma_f32_16x16x32_bf16 v[96:99], v[184:187], v[212:215], v[96:99]
  ds_read_b64 v[138:139], v54 offset:72
  v_mfma_f32_16x16x32_bf16 v[100:103], v[184:187], v[216:219], v[100:103]
  v_mfma_f32_16x16x32_bf16 v[104:107], v[184:187], v[220:223], v[104:107]
  v_mfma_f32_16x16x32_bf16 v[92:95], v[188:191], v[204:207], v[92:95]
  v_mfma_f32_16x16x32_bf16 v[96:99], v[188:191], v[208:211], v[96:99]
  v_mfma_f32_16x16x32_bf16 v[100:103], v[188:191], v[212:215], v[100:103]
  v_mfma_f32_16x16x32_bf16 v[104:107], v[188:191], v[216:219], v[104:107]
  v_mfma_f32_16x16x32_bf16 v[96:99], v[192:195], v[204:207], v[96:99]
  v_mfma_f32_16x16x32_bf16 v[100:103], v[192:195], v[208:211], v[100:103]
  v_mfma_f32_16x16x32_bf16 v[104:107], v[192:195], v[212:215], v[104:107]
  v_mfma_f32_16x16x32_bf16 v[100:103], v[196:199], v[204:207], v[100:103]
  v_mfma_f32_16x16x32_bf16 v[104:107], v[196:199], v[208:211], v[104:107]
  v_mfma_f32_16x16x32_bf16 v[104:107], v[200:203], v[204:207], v[104:107]
  s_waitcnt lgkmcnt(0)
  v_mfma_f32_16x16x32_bf16 v[76:79], v[108:111], v[140:143], v[76:79]
  ds_read_b128 v[204:207], v55 offset:0
  v_mfma_f32_16x16x32_bf16 v[80:83], v[108:111], v[144:147], v[80:83]
  ds_read_b64 v[172:173], v54 offset:3584
  v_mfma_f32_16x16x32_bf16 v[84:87], v[108:111], v[148:151], v[84:87]
  ds_read_b64 v[174:175], v54 offset:3592
  v_mfma_f32_16x16x32_bf16 v[88:91], v[108:111], v[152:155], v[88:91]
  ds_read_b128 v[208:211], v55 offset:512
  v_mfma_f32_16x16x32_bf16 v[92:95], v[108:111], v[156:159], v[92:95]
  ds_read_b64 v[176:177], v54 offset:3072
  v_mfma_f32_16x16x32_bf16 v[96:99], v[108:111], v[160:163], v[96:99]
  ds_read_b64 v[178:179], v54 offset:3080
  v_mfma_f32_16x16x32_bf16 v[100:103], v[108:111], v[164:167], v[100:103]
  ds_read_b128 v[212:215], v55 offset:1024
  v_mfma_f32_16x16x32_bf16 v[104:107], v[108:111], v[168:171], v[104:107]
  ds_read_b64 v[180:181], v54 offset:2560
  v_mfma_f32_16x16x32_bf16 v[80:83], v[112:115], v[140:143], v[80:83]
  ds_read_b64 v[182:183], v54 offset:2568
  v_mfma_f32_16x16x32_bf16 v[84:87], v[112:115], v[144:147], v[84:87]
  ds_read_b128 v[216:219], v55 offset:1536
  v_mfma_f32_16x16x32_bf16 v[88:91], v[112:115], v[148:151], v[88:91]
  ds_read_b64 v[184:185], v54 offset:2048
  v_mfma_f32_16x16x32_bf16 v[92:95], v[112:115], v[152:155], v[92:95]
  ds_read_b64 v[186:187], v54 offset:2056
  s_waitcnt lgkmcnt(6)
  v_mfma_f32_16x16x32_bf16 v[96:99], v[112:115], v[156:159], v[96:99]
  ds_read_b128 v[220:223], v55 offset:2048
  v_mfma_f32_16x16x32_bf16 v[100:103], v[112:115], v[160:163], v[100:103]
  ds_read_b64 v[188:189], v54 offset:1536
  v_mfma_f32_16x16x32_bf16 v[104:107], v[112:115], v[164:167], v[104:107]
  ds_read_b64 v[190:191], v54 offset:1544
  v_mfma_f32_16x16x32_bf16 v[84:87], v[116:119], v[140:143], v[84:87]
  ds_read_b128 v[224:227], v55 offset:2560
  v_mfma_f32_16x16x32_bf16 v[88:91], v[116:119], v[144:147], v[88:91]
  ds_read_b64 v[192:193], v54 offset:1024
  v_mfma_f32_16x16x32_bf16 v[92:95], v[116:119], v[148:151], v[92:95]
  ds_read_b64 v[194:195], v54 offset:1032
  v_mfma_f32_16x16x32_bf16 v[96:99], v[116:119], v[152:155], v[96:99]
  ds_read_b128 v[228:231], v55 offset:3072
  v_mfma_f32_16x16x32_bf16 v[100:103], v[116:119], v[156:159], v[100:103]
  ds_read_b64 v[196:197], v54 offset:512
  v_mfma_f32_16x16x32_bf16 v[104:107], v[116:119], v[160:163], v[104:107]
  ds_read_b64 v[198:199], v54 offset:520
  v_mfma_f32_16x16x32_bf16 v[88:91], v[120:123], v[140:143], v[88:91]
  ds_read_b128 v[232:235], v55 offset:3584
  v_mfma_f32_16x16x32_bf16 v[92:95], v[120:123], v[144:147], v[92:95]
  ds_read_b64 v[200:201], v54 offset:0
  v_mfma_f32_16x16x32_bf16 v[96:99], v[120:123], v[148:151], v[96:99]
  ds_read_b64 v[202:203], v54 offset:8
  v_mfma_f32_16x16x32_bf16 v[100:103], v[120:123], v[152:155], v[100:103]
  v_mfma_f32_16x16x32_bf16 v[104:107], v[120:123], v[156:159], v[104:107]
  v_mfma_f32_16x16x32_bf16 v[92:95], v[124:127], v[140:143], v[92:95]
  v_mfma_f32_16x16x32_bf16 v[96:99], v[124:127], v[144:147], v[96:99]
  v_mfma_f32_16x16x32_bf16 v[100:103], v[124:127], v[148:151], v[100:103]
  v_mfma_f32_16x16x32_bf16 v[104:107], v[124:127], v[152:155], v[104:107]
  v_mfma_f32_16x16x32_bf16 v[96:99], v[128:131], v[140:143], v[96:99]
  v_mfma_f32_16x16x32_bf16 v[100:103], v[128:131], v[144:147], v[100:103]
  v_mfma_f32_16x16x32_bf16 v[104:107], v[128:131], v[148:151], v[104:107]
  v_mfma_f32_16x16x32_bf16 v[100:103], v[132:135], v[140:143], v[100:103]
  v_mfma_f32_16x16x32_bf16 v[104:107], v[132:135], v[144:147], v[104:107]
  v_mfma_f32_16x16x32_bf16 v[104:107], v[136:139], v[140:143], v[104:107]
  s_waitcnt lgkmcnt(0)
  v_mfma_f32_16x16x32_bf16 v[76:79], v[172:175], v[204:207], v[76:79]
  v_mfma_f32_16x16x32_bf16 v[80:83], v[172:175], v[208:211], v[80:83]
  v_mfma_f32_16x16x32_bf16 v[84:87], v[172:175], v[212:215], v[84:87]
  v_mfma_f32_16x16x32_bf16 v[88:91], v[172:175], v[216:219], v[88:91]
  v_mfma_f32_16x16x32_bf16 v[92:95], v[172:175], v[220:223], v[92:95]
  v_mfma_f32_16x16x32_bf16 v[96:99], v[172:175], v[224:227], v[96:99]
  v_mfma_f32_16x16x32_bf16 v[100:103], v[172:175], v[228:231], v[100:103]
  v_mfma_f32_16x16x32_bf16 v[104:107], v[172:175], v[232:235], v[104:107]
  v_mfma_f32_16x16x32_bf16 v[80:83], v[176:179], v[204:207], v[80:83]
  v_mfma_f32_16x16x32_bf16 v[84:87], v[176:179], v[208:211], v[84:87]
  v_mfma_f32_16x16x32_bf16 v[88:91], v[176:179], v[212:215], v[88:91]
  v_mfma_f32_16x16x32_bf16 v[92:95], v[176:179], v[216:219], v[92:95]
  v_mfma_f32_16x16x32_bf16 v[96:99], v[176:179], v[220:223], v[96:99]
  v_mfma_f32_16x16x32_bf16 v[100:103], v[176:179], v[224:227], v[100:103]
  v_mfma_f32_16x16x32_bf16 v[104:107], v[176:179], v[228:231], v[104:107]
  v_mfma_f32_16x16x32_bf16 v[84:87], v[180:183], v[204:207], v[84:87]
  v_mfma_f32_16x16x32_bf16 v[88:91], v[180:183], v[208:211], v[88:91]
  v_mfma_f32_16x16x32_bf16 v[92:95], v[180:183], v[212:215], v[92:95]
  v_mfma_f32_16x16x32_bf16 v[96:99], v[180:183], v[216:219], v[96:99]
  v_mfma_f32_16x16x32_bf16 v[100:103], v[180:183], v[220:223], v[100:103]
  v_mfma_f32_16x16x32_bf16 v[104:107], v[180:183], v[224:227], v[104:107]
  v_mfma_f32_16x16x32_bf16 v[88:91], v[184:187], v[204:207], v[88:91]
  v_mfma_f32_16x16x32_bf16 v[92:95], v[184:187], v[208:211], v[92:95]
  v_mfma_f32_16x16x32_bf16 v[96:99], v[184:187], v[212:215], v[96:99]
  v_mfma_f32_16x16x32_bf16 v[100:103], v[184:187], v[216:219], v[100:103]
  v_mfma_f32_16x16x32_bf16 v[104:107], v[184:187], v[220:223], v[104:107]
  v_mfma_f32_16x16x32_bf16 v[92:95], v[188:191], v[204:207], v[92:95]
  v_mfma_f32_16x16x32_bf16 v[96:99], v[188:191], v[208:211], v[96:99]
  v_mfma_f32_16x16x32_bf16 v[100:103], v[188:191], v[212:215], v[100:103]
  v_mfma_f32_16x16x32_bf16 v[104:107], v[188:191], v[216:219], v[104:107]
  v_mfma_f32_16x16x32_bf16 v[96:99], v[192:195], v[204:207], v[96:99]
  v_mfma_f32_16x16x32_bf16 v[100:103], v[192:195], v[208:211], v[100:103]
  v_mfma_f32_16x16x32_bf16 v[104:107], v[192:195], v[212:215], v[104:107]
  v_mfma_f32_16x16x32_bf16 v[100:103], v[196:199], v[204:207], v[100:103]
  v_mfma_f32_16x16x32_bf16 v[104:107], v[196:199], v[208:211], v[104:107]
  v_mfma_f32_16x16x32_bf16 v[104:107], v[200:203], v[204:207], v[104:107]
  s_xor_b32 s75, s76, 0x5a5a5a5a
  s_waitcnt vmcnt(0)
  v_cmp_ne_u32 s[8:9], s76, v236
  v_cmp_ne_u32 s[10:11], s74, v237
  s_or_b64 s[8:9], s[8:9], s[10:11]
  s_cselect_b32 s73, 1, 0
  s_lshl_b32 s8, s3, 12
  s_add_u32 s8, s8, 42496
  v_lshl_add_u32 v42, v1, 4, s8
  s_xor_b32 s9, s3, 1
  s_lshl_b32 s9, s9, 12
  s_add_u32 s9, s9, 42496
  v_lshl_add_u32 v43, v1, 4, s9
  v_mov_b32 v125, s75
  v_mov_b32 v127, s74
  v_mov_b32 v129, s75
  v_mov_b32 v131, s74
  v_mov_b32 v133, s75
  v_mov_b32 v135, s74
  v_mov_b32 v137, s75
  v_mov_b32 v139, s74
  s_cmp_eq_u32 s12, 0
  s_cbranch_scc1 Lr1_33
  ds_write_b128 v42, v[76:79] offset:0
  ds_write_b128 v42, v[80:83] offset:1024
  ds_write_b128 v42, v[84:87] offset:2048
  ds_write_b128 v42, v[88:91] offset:3072
  s_waitcnt lgkmcnt(0)
  s_barrier
  ds_read_b128 v[108:111], v43 offset:0
  ds_read_b128 v[112:115], v43 offset:1024
  ds_read_b128 v[116:119], v43 offset:2048
  ds_read_b128 v[120:123], v43 offset:3072
  s_waitcnt lgkmcnt(3)
  v_pk_add_f32 v[92:93], v[92:93], v[108:109]
  v_pk_add_f32 v[94:95], v[94:95], v[110:111]
  v_cvt_pk_bf16_f32 v124, v92, v93
  v_cvt_pk_bf16_f32 v126, v94, v95
  s_waitcnt lgkmcnt(2)
  v_pk_add_f32 v[96:97], v[96:97], v[112:113]
  v_pk_add_f32 v[98:99], v[98:99], v[114:115]
  v_cvt_pk_bf16_f32 v128, v96, v97
  v_cvt_pk_bf16_f32 v130, v98, v99
  s_waitcnt lgkmcnt(1)
  v_pk_add_f32 v[100:101], v[100:101], v[116:117]
  v_pk_add_f32 v[102:103], v[102:103], v[118:119]
  v_cvt_pk_bf16_f32 v132, v100, v101
  v_cvt_pk_bf16_f32 v134, v102, v103
  s_waitcnt lgkmcnt(0)
  v_pk_add_f32 v[104:105], v[104:105], v[120:121]
  v_pk_add_f32 v[106:107], v[106:107], v[122:123]
  v_cvt_pk_bf16_f32 v136, v104, v105
  v_cvt_pk_bf16_f32 v138, v106, v107
  s_branch Lr2_34
Lr1_33:
  ds_write_b128 v42, v[92:95] offset:0
  ds_write_b128 v42, v[96:99] offset:1024
  ds_write_b128 v42, v[100:103] offset:2048
  ds_write_b128 v42, v[104:107] offset:3072
  s_waitcnt lgkmcnt(0)
  s_barrier
  ds_read_b128 v[108:111], v43 offset:0
  ds_read_b128 v[112:115], v43 offset:1024
  ds_read_b128 v[116:119], v43 offset:2048
  ds_read_b128 v[120:123], v43 offset:3072
  s_waitcnt lgkmcnt(3)
  v_pk_add_f32 v[76:77], v[76:77], v[108:109]
  v_pk_add_f32 v[78:79], v[78:79], v[110:111]
  v_cvt_pk_bf16_f32 v124, v76, v77
  v_cvt_pk_bf16_f32 v126, v78, v79
  s_waitcnt lgkmcnt(2)
  v_pk_add_f32 v[80:81], v[80:81], v[112:113]
  v_pk_add_f32 v[82:83], v[82:83], v[114:115]
  v_cvt_pk_bf16_f32 v128, v80, v81
  v_cvt_pk_bf16_f32 v130, v82, v83
  s_waitcnt lgkmcnt(1)
  v_pk_add_f32 v[84:85], v[84:85], v[116:117]
  v_pk_add_f32 v[86:87], v[86:87], v[118:119]
  v_cvt_pk_bf16_f32 v132, v84, v85
  v_cvt_pk_bf16_f32 v134, v86, v87
  s_waitcnt lgkmcnt(0)
  v_pk_add_f32 v[88:89], v[88:89], v[120:121]
  v_pk_add_f32 v[90:91], v[90:91], v[122:123]
  v_cvt_pk_bf16_f32 v136, v88, v89
  v_cvt_pk_bf16_f32 v138, v90, v91
Lr2_34:
  s_cmp_lg_u32 s73, 0
  s_cbranch_scc1 Lys_35
  global_store_dwordx4 v56, v[124:127], s[70:71] offset:0 nt
  global_store_dwordx4 v56, v[128:131], s[70:71] offset:1024 nt
  global_store_dwordx4 v56, v[132:135], s[70:71] offset:2048 nt
  global_store_dwordx4 v56, v[136:139], s[70:71] offset:3072 nt
  s_branch Lyj_36
Lys_35:
  global_store_dwordx4 v56, v[124:127], s[70:71] offset:0 sc1
  global_store_dwordx4 v56, v[128:131], s[70:71] offset:1024 sc1
  global_store_dwordx4 v56, v[132:135], s[70:71] offset:2048 sc1
  global_store_dwordx4 v56, v[136:139], s[70:71] offset:3072 sc1
Lyj_36:
  s_xor_b32 s8, s2, 256
  s_or_b32 s8, s8, s3
  s_cmp_lg_u32 s8, 0
  s_cbranch_scc1 Lep_skip_39
  v_lshlrev_b32 v4, 4, v1
  v_add_u32 v5, 151552, v4
  v_add_u32 v6, 131072, v4
  v_add_u32 v7, 147456, v4
  s_mov_b32 s13, 0
Lep_37:
  global_load_dwordx4 v[148:151], v5, s[66:67] offset:0 sc1
  global_load_dwordx4 v[152:155], v5, s[66:67] offset:1024 sc1
  global_load_dwordx4 v[164:167], v6, s[66:67] offset:0 sc1
  global_load_dwordx4 v[168:171], v6, s[66:67] offset:1024 sc1
  s_add_u32 s13, s13, 1
  v_mov_b32 v8, 0
  s_waitcnt vmcnt(0)
  v_xor_b32 v148, s76, v148
  v_and_or_b32 v8, v148, -1, v8
  v_xor_b32 v149, s77, v149
  v_and_or_b32 v8, v149, -8, v8
  v_xor_b32 v150, s76, v150
  v_and_or_b32 v8, v150, -1, v8
  v_xor_b32 v151, s77, v151
  v_and_or_b32 v8, v151, -8, v8
  v_xor_b32 v152, s76, v152
  v_and_or_b32 v8, v152, -1, v8
  v_xor_b32 v153, s77, v153
  v_and_or_b32 v8, v153, -8, v8
  v_xor_b32 v154, s76, v154
  v_and_or_b32 v8, v154, -1, v8
  v_xor_b32 v155, s77, v155
  v_and_or_b32 v8, v155, -8, v8
  v_xor_b32 v164, s76, v164
  v_and_or_b32 v8, v164, -1, v8
  v_xor_b32 v165, s77, v165
  v_and_or_b32 v8, v165, -8, v8
  v_xor_b32 v166, s76, v166
  v_and_or_b32 v8, v166, -1, v8
  v_xor_b32 v167, s77, v167
  v_and_or_b32 v8, v167, -8, v8
  v_xor_b32 v168, s76, v168
  v_and_or_b32 v8, v168, -1, v8
  v_xor_b32 v169, s77, v169
  v_and_or_b32 v8, v169, -8, v8
  v_xor_b32 v170, s76, v170
  v_and_or_b32 v8, v170, -1, v8
  v_xor_b32 v171, s77, v171
  v_and_or_b32 v8, v171, -8, v8
  v_cmp_ne_u32 vcc, 0, v8
  s_cbranch_vccz Lep_done_38
  s_sleep 8
  s_cmp_lt_u32 s13, 131072
  s_cbranch_scc1 Lep_37
Lep_done_38:
  v_mov_b32 v4, s76
  v_mov_b32 v5, s77
  s_mov_b64 exec, 1
  global_store_dwordx2 v2, v[4:5], s[56:57] sc1
  s_mov_b64 exec, -1
Lep_skip_39:
  v_lshlrev_b32 v252, 16, v252
  v_lshlrev_b32 v60, 16, v60
  v_lshlrev_b32 v61, 16, v61
  v_mul_f32 v60, v60, v252
  v_mul_f32 v61, v61, v252
  v_cvt_pk_bf16_f32 v60, v60, v61
  v_and_b32 v61, 0xffff0000, v60
  v_lshlrev_b32 v60, 16, v60
  v_lshlrev_b32 v62, 16, v62
  v_lshlrev_b32 v63, 16, v63
  v_mul_f32 v62, v62, v252
  v_mul_f32 v63, v63, v252
  v_cvt_pk_bf16_f32 v62, v62, v63
  v_and_b32 v63, 0xffff0000, v62
  v_lshlrev_b32 v62, 16, v62
  v_lshlrev_b32 v64, 16, v64
  v_lshlrev_b32 v65, 16, v65
  v_mul_f32 v64, v64, v252
  v_mul_f32 v65, v65, v252
  v_cvt_pk_bf16_f32 v64, v64, v65
  v_and_b32 v65, 0xffff0000, v64
  v_lshlrev_b32 v64, 16, v64
  v_lshlrev_b32 v66, 16, v66
  v_lshlrev_b32 v67, 16, v67
  v_mul_f32 v66, v66, v252
  v_mul_f32 v67, v67, v252
  v_cvt_pk_bf16_f32 v66, v66, v67
  v_and_b32 v67, 0xffff0000, v66
  v_lshlrev_b32 v66, 16, v66
  v_lshlrev_b32 v68, 16, v68
  v_lshlrev_b32 v69, 16, v69
  v_mul_f32 v68, v68, v252
  v_mul_f32 v69, v69, v252
  v_cvt_pk_bf16_f32 v68, v68, v69
  v_and_b32 v69, 0xffff0000, v68
  v_lshlrev_b32 v68, 16, v68
  v_lshlrev_b32 v70, 16, v70
  v_lshlrev_b32 v71, 16, v71
  v_mul_f32 v70, v70, v252
  v_mul_f32 v71, v71, v252
  v_cvt_pk_bf16_f32 v70, v70, v71
  v_and_b32 v71, 0xffff0000, v70
  v_lshlrev_b32 v70, 16, v70
  v_lshlrev_b32 v72, 16, v72
  v_lshlrev_b32 v73, 16, v73
  v_mul_f32 v72, v72, v252
  v_mul_f32 v73, v73, v252
  v_cvt_pk_bf16_f32 v72, v72, v73
  v_and_b32 v73, 0xffff0000, v72
  v_lshlrev_b32 v72, 16, v72
  v_lshlrev_b32 v74, 16, v74
  v_lshlrev_b32 v75, 16, v75
  v_mul_f32 v74, v74, v252
  v_mul_f32 v75, v75, v252
  v_cvt_pk_bf16_f32 v74, v74, v75
  v_and_b32 v75, 0xffff0000, v74
  v_lshlrev_b32 v74, 16, v74
  global_load_dwordx4 v[176:179], v47, s[70:71] offset:0
  global_load_dwordx4 v[180:183], v47, s[70:71] offset:256
  global_load_dwordx4 v[184:187], v47, s[70:71] offset:512
  global_load_dwordx4 v[188:191], v47, s[70:71] offset:768
  s_mov_b32 s13, 0
  s_branch Lyf_chk_42
Lyf_40:
  s_sleep 6
  s_mov_b64 exec, s[36:37]
  s_cbranch_execz Lyf_s_44
  global_load_dwordx4 v[176:179], v47, s[70:71] offset:0 sc1
Lyf_s_44:
  s_mov_b64 exec, s[38:39]
  s_cbranch_execz Lyf_s_45
  global_load_dwordx4 v[180:183], v47, s[70:71] offset:256 sc1
Lyf_s_45:
  s_mov_b64 exec, s[40:41]
  s_cbranch_execz Lyf_s_46
  global_load_dwordx4 v[184:187], v47, s[70:71] offset:512 sc1
Lyf_s_46:
  s_mov_b64 exec, s[42:43]
  s_cbranch_execz Lyf_s_47
  global_load_dwordx4 v[188:191], v47, s[70:71] offset:768 sc1
Lyf_s_47:
  s_mov_b64 exec, -1
  s_add_u32 s13, s13, 1
Lyf_chk_42:
  s_waitcnt vmcnt(0)
Lyf_chk2_43:
  v_mov_b32 v251, 0
  v_xor_b32 v253, s75, v177
  v_xor_b32 v254, s74, v179
  v_or_b32 v251, v251, v254
  v_and_or_b32 v253, v254, -8, v253
  v_cmp_ne_u32 s[36:37], 0, v253
  v_xor_b32 v253, s75, v181
  v_xor_b32 v254, s74, v183
  v_or_b32 v251, v251, v254
  v_and_or_b32 v253, v254, -8, v253
  v_cmp_ne_u32 s[38:39], 0, v253
  v_xor_b32 v253, s75, v185
  v_xor_b32 v254, s74, v187
  v_or_b32 v251, v251, v254
  v_and_or_b32 v253, v254, -8, v253
  v_cmp_ne_u32 s[40:41], 0, v253
  v_xor_b32 v253, s75, v189
  v_xor_b32 v254, s74, v191
  v_or_b32 v251, v251, v254
  v_and_or_b32 v253, v254, -8, v253
  v_cmp_ne_u32 s[42:43], 0, v253
  s_or_b64 s[8:9], s[36:37], s[38:39]
  s_or_b64 s[10:11], s[40:41], s[42:43]
  s_or_b64 s[8:9], s[8:9], s[10:11]
  s_cbranch_scc0 Lyf_done_41
  s_cmp_lt_u32 s13, 131072
  s_cbranch_scc1 Lyf_40
Lyf_done_41:
  ds_write2_b32 v59, v176, v178 offset0:0 offset1:1
  ds_write2_b32 v59, v180, v182 offset0:2 offset1:3
  ds_write2_b32 v59, v184, v186 offset0:4 offset1:5
  ds_write2_b32 v59, v188, v190 offset0:6 offset1:7
  s_waitcnt lgkmcnt(0)
  s_barrier
  ds_read_b128 v[176:179], v3
  ds_read_b128 v[180:183], v3 offset:16
  s_waitcnt lgkmcnt(1)
  v_lshlrev_b32 v76, 16, v176
  v_and_b32 v77, 0xffff0000, v176
  v_pk_add_f32 v[76:77], v[76:77], v[60:61]
  v_cvt_pk_bf16_f32 v176, v76, v77
  v_lshlrev_b32 v76, 16, v176
  v_and_b32 v77, 0xffff0000, v176
  s_mov_b32 s8, 0
  buffer_store_dword v76, v46, s[80:83], s8 offen nt
  s_mov_b32 s9, 4096
  buffer_store_dword v77, v46, s[80:83], s9 offen nt
  v_lshlrev_b32 v78, 16, v177
  v_and_b32 v79, 0xffff0000, v177
  v_pk_add_f32 v[78:79], v[78:79], v[62:63]
  v_cvt_pk_bf16_f32 v177, v78, v79
  v_lshlrev_b32 v78, 16, v177
  v_and_b32 v79, 0xffff0000, v177
  s_mov_b32 s8, 8192
  buffer_store_dword v78, v46, s[80:83], s8 offen nt
  s_mov_b32 s9, 12288
  buffer_store_dword v79, v46, s[80:83], s9 offen nt
  v_lshlrev_b32 v80, 16, v178
  v_and_b32 v81, 0xffff0000, v178
  v_pk_add_f32 v[80:81], v[80:81], v[64:65]
  v_cvt_pk_bf16_f32 v178, v80, v81
  v_lshlrev_b32 v80, 16, v178
  v_and_b32 v81, 0xffff0000, v178
  s_mov_b32 s8, 16384
  buffer_store_dword v80, v46, s[80:83], s8 offen nt
  s_mov_b32 s9, 20480
  buffer_store_dword v81, v46, s[80:83], s9 offen nt
  v_lshlrev_b32 v82, 16, v179
  v_and_b32 v83, 0xffff0000, v179
  v_pk_add_f32 v[82:83], v[82:83], v[66:67]
  v_cvt_pk_bf16_f32 v179, v82, v83
  v_lshlrev_b32 v82, 16, v179
  v_and_b32 v83, 0xffff0000, v179
  s_mov_b32 s8, 24576
  buffer_store_dword v82, v46, s[80:83], s8 offen nt
  s_mov_b32 s9, 28672
  buffer_store_dword v83, v46, s[80:83], s9 offen nt
  s_waitcnt lgkmcnt(0)
  v_lshlrev_b32 v84, 16, v180
  v_and_b32 v85, 0xffff0000, v180
  v_pk_add_f32 v[84:85], v[84:85], v[68:69]
  v_cvt_pk_bf16_f32 v180, v84, v85
  v_lshlrev_b32 v84, 16, v180
  v_and_b32 v85, 0xffff0000, v180
  s_mov_b32 s8, 32768
  buffer_store_dword v84, v46, s[80:83], s8 offen nt
  s_mov_b32 s9, 36864
  buffer_store_dword v85, v46, s[80:83], s9 offen nt
  v_lshlrev_b32 v86, 16, v181
  v_and_b32 v87, 0xffff0000, v181
  v_pk_add_f32 v[86:87], v[86:87], v[70:71]
  v_cvt_pk_bf16_f32 v181, v86, v87
  v_lshlrev_b32 v86, 16, v181
  v_and_b32 v87, 0xffff0000, v181
  s_mov_b32 s8, 40960
  buffer_store_dword v86, v46, s[80:83], s8 offen nt
  s_mov_b32 s9, 45056
  buffer_store_dword v87, v46, s[80:83], s9 offen nt
  v_lshlrev_b32 v88, 16, v182
  v_and_b32 v89, 0xffff0000, v182
  v_pk_add_f32 v[88:89], v[88:89], v[72:73]
  v_cvt_pk_bf16_f32 v182, v88, v89
  v_lshlrev_b32 v88, 16, v182
  v_and_b32 v89, 0xffff0000, v182
  s_mov_b32 s8, 49152
  buffer_store_dword v88, v46, s[80:83], s8 offen nt
  s_mov_b32 s9, 53248
  buffer_store_dword v89, v46, s[80:83], s9 offen nt
  v_lshlrev_b32 v90, 16, v183
  v_and_b32 v91, 0xffff0000, v183
  v_pk_add_f32 v[90:91], v[90:91], v[74:75]
  v_cvt_pk_bf16_f32 v183, v90, v91
  v_lshlrev_b32 v90, 16, v183
  v_and_b32 v91, 0xffff0000, v183
  s_mov_b32 s8, 57344
  buffer_store_dword v90, v46, s[80:83], s8 offen nt
  s_mov_b32 s9, 61440
  buffer_store_dword v91, v46, s[80:83], s9 offen nt
WARMEND_B:
L_end:
  s_endpgm

.section .rodata,"a"
.p2align 6
.amdhsa_kernel concat_heads__ssm_conv_s5__ssm_conv_s4__prompt_kernel
  .amdhsa_next_free_vgpr 256
  .amdhsa_next_free_sgpr 102
  .amdhsa_accum_offset 256
  .amdhsa_group_segment_fixed_size 0
  .amdhsa_kernarg_size 168
  .amdhsa_user_sgpr_count 2
  .amdhsa_user_sgpr_kernarg_segment_ptr 1
  .amdhsa_system_sgpr_workgroup_id_x 1
.end_amdhsa_kernel
```
